```python
import torch

def _softmax(x, axis=-1):
    return torch.softmax(x, dim=axis)

def _gelu(x):
    return torch.nn.functional.gelu(x, approximate='tanh')

def _silu(x):
    return torch.nn.functional.silu(x)

def _sigmoid(x):
    return torch.sigmoid(x)

def _layernorm(x, axis=-1, eps=1e-05):
    m = x.mean(dim=axis, keepdim=True)
    v = x.var(dim=axis, keepdim=True, unbiased=False)
    return (x - m) / torch.sqrt(v + eps)

def _scatter_add(tgt, idx, src, axis=0):
    return tgt.clone().index_add_(axis, idx, src)

def _segment_sum(src, seg, n):
    out = torch.zeros((n,) + src.shape[1:], dtype=src.dtype)
    return out.index_add_(0, seg, src)

def _pad(x, pw):
    flat = tuple((v for pair in reversed(pw) for v in pair))
    return torch.nn.functional.pad(x, flat)
kernel_name = 'adaLN_cond__gqa_block_cached__mixer_channel_mlp__decode'

def setup_inputs():

    _w = lambda a: (lambda t: t.to(torch.bfloat16) if t.is_floating_point() else t)(torch.as_tensor(a))

    def _A_setup():
        B, Sq, D = (2, 1, 512)
        Hq, Hkv, Sk, Dh = (32, 8, 8192, 128)
        assert Hq % Hkv == 0, (Hq, Hkv)
        return {'x': _w((lambda *s: torch.randn(*s, dtype=torch.bfloat16) * 0.1)(B, Sq, D)), 'k_cache': _w((lambda *s: torch.randn(*s, dtype=torch.bfloat16) * 0.8)(B, Hkv, Sk, Dh)), 'v_cache': _w((lambda *s: torch.randn(*s, dtype=torch.bfloat16) * 0.8)(B, Hkv, Sk, Dh)), 'wq': _w((lambda *s: torch.randn(*s, dtype=torch.bfloat16) * 0.8)(D, Hq * Dh) * D ** (-0.5)), 'wo': _w((lambda *s: torch.randn(*s, dtype=torch.bfloat16) * 0.8)(Hq * Dh, D) * (Hq * Dh) ** (-0.5))}
    _A_in = _A_setup()

    def _B_setup():
        B, S, D, F = (2, 1, 512, 1792)
        return {'x': _w((lambda *s: torch.randn(*s, dtype=torch.bfloat16) * 0.1)(B, S, D)), 'w1': _w((lambda *s: torch.randn(*s, dtype=torch.bfloat16) * 3.2)(D, F) * D ** (-0.5)), 'b1': _w((lambda *s: torch.randn(*s, dtype=torch.bfloat16) * 3.2)(F)), 'w2': _w((lambda *s: torch.randn(*s, dtype=torch.bfloat16) * 3.2)(F, D) * F ** (-0.5)), 'b2': _w((lambda *s: torch.randn(*s, dtype=torch.bfloat16) * 3.2)(D))}
    _B_in = _B_setup()
    return {'A_x': _A_in['x'], 'A_k_cache': _A_in['k_cache'], 'A_v_cache': _A_in['v_cache'], 'A_wq': _A_in['wq'], 'A_wo': _A_in['wo'], 'B_x': _B_in['x'], 'B_w1': _B_in['w1'], 'B_b1': _B_in['b1'], 'B_w2': _B_in['w2'], 'B_b2': _B_in['b2'], 'c': _w((lambda *s: torch.randn(*s, dtype=torch.bfloat16) * 0.4)(2, 512) * 8.0), 'w_mod': _w((lambda *s: torch.randn(*s, dtype=torch.bfloat16) * 0.4)(512, 6 * 512) * 512 ** (-0.5) * 8.0)}

def reference(A_x, A_k_cache, A_v_cache, A_wq, A_wo, B_x, B_w1, B_b1, B_w2, B_b2, c, w_mod):

    def _A_ref(x, k_cache, v_cache, wq, wo):
        B, Sq, D = x.shape
        Hq, Dh = (32, 128)
        Hkv = k_cache.shape[1]
        rep = Hq // Hkv
        q = (lambda x, *d: x.permute(*d))((x @ wq).reshape(B, Sq, Hq, Dh), 0, 2, 1, 3)
        k = (lambda x, n, axis: torch.repeat_interleave(x, n, dim=axis))(k_cache, rep, axis=1)
        v = (lambda x, n, axis: torch.repeat_interleave(x, n, dim=axis))(v_cache, rep, axis=1)
        scores = torch.einsum('bhqd,bhkd->bhqk', q, k) * Dh ** (-0.5)
        p = _softmax(scores, axis=-1)
        o = torch.einsum('bhqk,bhkd->bhqd', p, v)
        return (lambda x, *d: x.permute(*d))(o, 0, 2, 1, 3).reshape(B, Sq, Hq * Dh) @ wo

    def _B_ref(x, w1, b1, w2, b2):
        y = _layernorm(x, axis=-1)
        h = _gelu(torch.einsum('bsd,df->bsf', y, w1) + b1)
        return torch.einsum('bsf,fd->bsd', h, w2) + b2
    x = A_x
    mod = (_silu(c) @ w_mod).reshape(c.shape[0], 6, 1, -1)
    sa, ca, ga, sb, cb, gb = (mod[:, 0].clone(), mod[:, 1].clone(), mod[:, 2].clone(), mod[:, 3].clone(), mod[:, 4].clone(), mod[:, 5].clone())
    h = _layernorm(x, axis=-1) * (1 + ca) + sa
    x = x + ga * _A_ref(h, A_k_cache, A_v_cache, A_wq, A_wo)
    h = _layernorm(x, axis=-1) * (1 + cb) + sb
    x = x + gb * _B_ref(h, B_w1, B_b1, B_w2, B_b2)
    return x
```

```asm
; @launch grid=(256,1,1) block=(768,1,1) lds=155648
.amdgcn_target "amdgcn-amd-amdhsa--gfx950"
.text
.globl adaLN_cond__gqa_block_cached__mixer_channel_mlp__decode_kernel
.p2align 8
.type adaLN_cond__gqa_block_cached__mixer_channel_mlp__decode_kernel,@function
adaLN_cond__gqa_block_cached__mixer_channel_mlp__decode_kernel:
L_top:
    s_load_dwordx4 s[8:11], s[0:1], 8
    v_lshrrev_b32 v1, 6, v0
    s_lshr_b32 s3, s2, 3
    s_and_b32 s5, s2, 7
    v_readfirstlane_b32 s4, v1
    s_load_dwordx4 s[12:15], s[0:1], 104
    s_mul_i32 s6, s3, 7
    s_add_u32 s6, s6, s5
    s_cmp_eq_u32 s5, 0
    s_cselect_b32 s6, 0, s6
    v_and_b32 v1, 63, v0
    s_sub_u32 s7, s6, 33
    s_cbranch_scc0 L_stream
L_hearly:
    s_cmp_ge_u32 s2, 256
    s_cbranch_scc1 L_end
    s_sub_u32 s6, s6, 1
    s_cmp_eq_u32 s5, 0
    s_cselect_b32 s3, s3, s6
    s_cmp_lt_u32 s4, 8
    s_cbranch_scc1 L_hm
    s_lshr_b32 s6, s2, 4
    s_xor_b32 s7, s4, 11
    s_or_b32 s6, s6, s7
    s_cbranch_scc1 L_spare
    s_getpc_b64 s[36:37]
L_pc:
    s_sub_u32 s36, s36, L_pc-L_top
    s_subb_u32 s37, s37, 0
    v_lshlrev_b32 v2, 7, v1
    s_mov_b32 s38, L_end-L_top
    s_mov_b32 s39, 0x20000
    s_mov_b32 s6, 8192
    buffer_load_dword v4, v2, s[36:39], 0 offen
    buffer_load_dword v5, v2, s[36:39], s6 offen
    s_endpgm
L_hm:
    s_cmp_eq_u32 s5, 0
    s_cselect_b32 s6, 88, 24
    s_load_dwordx2 s[20:21], s[0:1], s6
    s_mov_b32 s7, 8192
    s_cselect_b32 s7, 6144, s7
    s_cselect_b32 s29, 2, 4
    s_cselect_b32 s24, 5, 6
    s_lshl_b32 s22, s7, 9
    s_lshl_b32 s25, s3, 8
    s_lshr_b32 s26, s3, 1
    s_lshl_b32 s26, s26, 7
    s_and_b32 s27, s3, 1
    s_mul_i32 s27, s27, 256*6144
    s_add_u32 s26, s26, s27
    s_cmp_eq_u32 s5, 0
    s_cselect_b32 s25, s26, s25
    v_bfe_u32 v10, v1, 4, 1
    v_and_b32 v12, 7, v1
    v_xor_b32 v10, v10, v12
    s_and_b32 s27, s4, 4
    v_xor_b32 v10, s27, v10
    v_lshrrev_b32 v2, 3, v1
    v_mul_u32_u24 v2, s7, v2
    v_xor_b32 v12, 2, v10
    v_lshl_add_u32 v12, v12, 4, v2
    v_lshl_add_u32 v2, v10, 4, v2
    s_mov_b32 s23, 0x20000
    s_lshl_b32 s6, s4, s24
    s_mul_i32 s27, s6, s7
    s_add_u32 s27, s27, s25
    s_lshl_b32 s28, s6, 7
    s_lshl_b32 s7, s7, 3
    s_waitcnt lgkmcnt(0)
L_hdma:
    s_mov_b32 m0, s28
    s_add_u32 s28, s28, 1024
    buffer_load_dwordx4 v2, s[20:23], s27 offen nt lds
    s_add_u32 s27, s27, s7
    s_mov_b32 m0, s28
    s_add_u32 s28, s28, 1024
    buffer_load_dwordx4 v12, s[20:23], s27 offen nt lds
    s_add_u32 s27, s27, s7
    s_sub_u32 s29, s29, 1
    s_cmp_lg_u32 s29, 0
    s_cbranch_scc1 L_hdma
    s_branch L_helper
L_stream:
    s_lshr_b32 s25, s7, 4
    s_and_b32 s24, s7, 15
    s_cmp_ge_u32 s25, 12
    s_cbranch_scc1 L_end
    s_mul_i32 s6, s25, 178962432
    s_lshr_b32 s7, s6, 18
    s_add_u32 s6, s6, 178962432
    s_lshr_b32 s6, s6, 18
    s_sub_u32 s31, s6, s7
    s_lshl_b32 s6, s24, 13
    s_add_u32 s6, s6, s7
    s_lshl_b32 s6, s6, 8
    s_mov_b32 s23, 0x20000
    s_cmp_ge_u32 s4, 4
    s_cbranch_scc1 L_vwave
    v_lshrrev_b32 v7, 4, v1
    v_and_b32 v15, 15, v1
    v_lshlrev_b32 v6, 2, v7
    v_xor_b32 v6, v6, v15
    v_lshlrev_b32 v8, 8, v7
    v_lshl_add_u32 v2, v6, 4, v8
    s_mul_i32 s27, s4, 44032
    s_mul_i32 s28, s4, 36864
    s_add_u32 s22, s27, 22016
    s_mov_b32 m0, s28
    s_waitcnt lgkmcnt(0)
    s_add_u32 s20, s8, s6
    s_addc_u32 s21, s9, 0
    buffer_load_dwordx4 v2, s[20:23], s27 offen nt lds
    s_setprio 3
    v_xor_b32 v3, 16, v2
    buffer_load_dwordx4 v3, s[20:23], s27 offen offset:1024 nt lds
    v_xor_b32 v4, 32, v2
    buffer_load_dwordx4 v4, s[20:23], s27 offen offset:2048 nt lds
    v_xor_b32 v5, 48, v2
    buffer_load_dwordx4 v5, s[20:23], s27 offen offset:3072 nt lds
    s_lshl_b32 s26, s24, 14
    s_lshl_b32 s7, s25, 10
    s_add_u32 s26, s26, s7
    s_lshl_b32 s7, s4, 8
    s_add_u32 s26, s26, s7
    s_add_u32 s26, s26, 262144
    v_mov_b32 v156, -1
    v_lshl_add_u32 v157, v1, 2, s26
    global_store_dword v157, v156, s[14:15] sc1
    s_mov_b32 s44, s22
    s_add_u32 s45, s44, 22016
    s_lshl_b32 s7, s31, 8
    s_min_u32 s45, s45, s7
    s_add_u32 s28, s28, 4096
    s_add_u32 s27, s27, 4096
    s_mov_b32 s29, 1
L_kdma:
    s_mov_b32 m0, s28
    s_add_u32 s28, s28, 4096
    s_add_u32 s29, s29, 1
    buffer_load_dwordx4 v2, s[20:23], s27 offen offset:0 nt lds
    buffer_load_dwordx4 v3, s[20:23], s27 offen offset:1024 nt lds
    buffer_load_dwordx4 v4, s[20:23], s27 offen offset:2048 nt lds
    buffer_load_dwordx4 v5, s[20:23], s27 offen offset:3072 nt lds
    s_add_u32 s27, s27, 4096
    s_cmp_eq_u32 s29, 6
    s_cselect_b32 s27, s44, s27
    s_cselect_b32 s22, s45, s22
    s_cmp_lt_u32 s29, 9
    s_cbranch_scc1 L_kdma
    s_load_dword s33, s[14:15], 108544
    v_and_b32 v6, 3, v15
    v_lshlrev_b32 v6, 2, v6
    v_lshrrev_b32 v9, 2, v15
    v_add_u32 v6, v6, v9
    v_lshlrev_b32 v10, 8, v6
    v_lshl_add_u32 v6, v7, 4, v10
    buffer_load_dwordx4 v[96:99], v6, s[20:23], s27 offen offset:0 nt
    buffer_load_dwordx4 v[100:103], v6, s[20:23], s27 offen offset:64 nt
    buffer_load_dwordx4 v[104:107], v6, s[20:23], s27 offen offset:128 nt
    buffer_load_dwordx4 v[108:111], v6, s[20:23], s27 offen offset:192 nt
    s_add_u32 s27, s27, 4096
    buffer_load_dwordx4 v[112:115], v6, s[20:23], s27 offen offset:0 nt
    buffer_load_dwordx4 v[116:119], v6, s[20:23], s27 offen offset:64 nt
    buffer_load_dwordx4 v[120:123], v6, s[20:23], s27 offen offset:128 nt
    buffer_load_dwordx4 v[124:127], v6, s[20:23], s27 offen offset:192 nt
    s_add_u32 s27, s27, 4096
    buffer_load_dwordx4 v[128:131], v6, s[20:23], s27 offen offset:0 nt
    buffer_load_dwordx4 v[132:135], v6, s[20:23], s27 offen offset:64 nt
    buffer_load_dwordx4 v[136:139], v6, s[20:23], s27 offen offset:128 nt
    buffer_load_dwordx4 v[140:143], v6, s[20:23], s27 offen offset:192 nt
    s_mov_b32 s16, s14
    s_mov_b32 s17, s15
    s_mov_b32 s18, 1048576
    s_mov_b32 s19, 0x20000
    s_and_b32 s7, s24, 7
    s_lshl_b32 s6, s7, 12
    s_lshr_b32 s7, s24, 3
    s_lshl_b32 s7, s7, 11
    s_add_u32 s27, s6, s7
    s_add_u32 s27, s27, 65536
    v_lshlrev_b32 v12, 4, v1
    s_barrier
    s_mul_i32 s28, s4, 36864
    v_and_b32 v11, 3, v15
    v_xor_b32 v11, v11, v7
    v_lshl_add_u32 v11, v9, 2, v11
    v_lshl_add_u32 v11, v11, 4, v10
    v_add_u32 v8, s28, v11
    v_xor_b32 v9, 64, v8
    v_xor_b32 v10, 128, v8
    v_xor_b32 v11, 192, v8
    s_mul_i32 s6, s4, 1536
    s_add_u32 s6, s6, 147456
    v_lshrrev_b32 v13, 3, v15
    v_lshlrev_b32 v13, 8, v13
    v_and_b32 v14, 3, v15
    v_lshl_add_u32 v13, v14, 6, v13
    v_lshl_add_u32 v13, v7, 4, v13
    v_bfe_u32 v14, v15, 2, 1
    v_lshl_add_u32 v13, v14, 3, v13
    v_add_u32 v13, s6, v13
    s_mov_b32 s36, 0xf000f
    s_mov_b32 s37, 0xf000f
    s_mov_b32 s38, 0xf000f0
    s_mov_b32 s39, 0xf000f0
    s_mov_b32 s40, 0xf000f00
    s_mov_b32 s41, 0xf000f00
    s_mov_b32 s42, 0xf000f000
    s_mov_b32 s43, 0xf000f000
    s_sub_u32 s6, s45, s44
    s_lshr_b32 s6, s6, 8
    s_sub_u32 s6, s6, 80
    v_sub_u32 v160, 6, v7
    v_cndmask_b32 v161, 64, v160, s[38:39]
    v_sub_u32 v160, s6, v7
    v_cndmask_b32 v163, 64, v160, s[42:43]
    s_waitcnt lgkmcnt(0)
    s_mul_i32 s33, s33, 0x9E3779B1
    s_add_u32 s33, s33, 0x85EBCA6B
    v_mov_b32 v14, 155392
    s_cmp_lg_u32 s4, 0
    s_cbranch_scc1 L_nq2
    s_waitcnt vmcnt(0)
    s_mov_b32 s30, 0
L_vp_1:
    buffer_load_dwordx4 v[32:35], v12, s[16:19], s27 offen offset:0 sc1
    buffer_load_dwordx4 v[36:39], v12, s[16:19], s27 offen offset:1024 sc1
    s_add_u32 s30, s30, 1
    s_waitcnt vmcnt(0)
    v_max3_u32 v164, v33, v35, v37
    v_max_u32 v164, v164, v39
    v_min3_u32 v165, v33, v35, v37
    v_min_u32 v165, v165, v39
    v_cmp_ne_u32 vcc, s33, v164
    v_cmp_ne_u32 s[34:35], s33, v165
    s_nop 0
    s_or_b64 vcc, vcc, s[34:35]
    s_cbranch_vccz L_vd_2
    s_sleep 4
    s_cmp_lt_u32 s30, 1000000
    s_cbranch_scc1 L_vp_1
L_vd_2:
    v_lshlrev_b32 v12, 3, v1
    v_add_u32 v12, 154368, v12
    v_mov_b32 v16, 1
    ds_write2_b32 v12, v32, v34 offset0:0 offset1:1
    ds_write2_b32 v12, v36, v38 offset0:128 offset1:129
    s_waitcnt lgkmcnt(0)
    ds_write_b32 v14, v16
    s_branch L_nq3
L_nq2:
    s_mov_b32 s30, 0
L_qspin:
    ds_read_b32 v16, v14
    s_add_u32 s30, s30, 1
    s_waitcnt lgkmcnt(0)
    v_cmp_ne_u32 vcc, 1, v16
    s_cbranch_vccz L_nq3
    s_sleep 1
    s_cmp_lt_u32 s30, 8000000
    s_cbranch_scc1 L_qspin
L_nq3:
    v_and_b32 v12, 3, v15
    v_lshlrev_b32 v12, 8, v12
    v_lshl_add_u32 v12, v7, 4, v12
    v_add_u32 v12, 154368, v12
    ds_read_b128 v[16:19], v12 offset:0
    ds_read_b128 v[20:23], v12 offset:64
    ds_read_b128 v[24:27], v12 offset:128
    ds_read_b128 v[28:31], v12 offset:192
    s_waitcnt vmcnt(0) lgkmcnt(0)
    ds_read_b128 v[64:67], v8 offset:0
    ds_read_b128 v[68:71], v9 offset:0
    ds_read_b128 v[72:75], v10 offset:0
    ds_read_b128 v[76:79], v11 offset:0
    v_cndmask_b32 v32, 0, v16, s[36:37]
    v_cndmask_b32 v33, 0, v17, s[36:37]
    v_cndmask_b32 v34, 0, v18, s[36:37]
    v_cndmask_b32 v35, 0, v19, s[36:37]
    v_cndmask_b32 v36, 0, v20, s[36:37]
    v_cndmask_b32 v37, 0, v21, s[36:37]
    v_cndmask_b32 v38, 0, v22, s[36:37]
    v_cndmask_b32 v39, 0, v23, s[36:37]
    v_cndmask_b32 v40, 0, v24, s[36:37]
    v_cndmask_b32 v41, 0, v25, s[36:37]
    v_cndmask_b32 v42, 0, v26, s[36:37]
    v_cndmask_b32 v43, 0, v27, s[36:37]
    v_cndmask_b32 v44, 0, v28, s[36:37]
    v_cndmask_b32 v45, 0, v29, s[36:37]
    v_cndmask_b32 v46, 0, v30, s[36:37]
    v_cndmask_b32 v47, 0, v31, s[36:37]
    ds_read_b128 v[80:83], v8 offset:16384
    ds_read_b128 v[84:87], v9 offset:16384
    ds_read_b128 v[88:91], v10 offset:16384
    ds_read_b128 v[92:95], v11 offset:16384
    s_waitcnt lgkmcnt(4)
    v_mfma_f32_16x16x32_bf16 v[144:147], v[64:67], v[32:35], 0
    v_cndmask_b32 v48, 0, v16, s[38:39]
    v_cndmask_b32 v49, 0, v17, s[38:39]
    v_mfma_f32_16x16x32_bf16 v[144:147], v[68:71], v[36:39], v[144:147]
    v_cndmask_b32 v50, 0, v18, s[38:39]
    v_cndmask_b32 v51, 0, v19, s[38:39]
    v_mfma_f32_16x16x32_bf16 v[144:147], v[72:75], v[40:43], v[144:147]
    v_cndmask_b32 v52, 0, v20, s[38:39]
    v_cndmask_b32 v53, 0, v21, s[38:39]
    v_mfma_f32_16x16x32_bf16 v[144:147], v[76:79], v[44:47], v[144:147]
    v_cndmask_b32 v54, 0, v22, s[38:39]
    v_cndmask_b32 v55, 0, v23, s[38:39]
    ds_read_b128 v[64:67], v8 offset:32768
    ds_read_b128 v[68:71], v9 offset:32768
    ds_read_b128 v[72:75], v10 offset:32768
    ds_read_b128 v[76:79], v11 offset:32768
    s_waitcnt lgkmcnt(4)
    v_mfma_f32_16x16x32_bf16 v[148:151], v[80:83], v[32:35], 0
    v_cndmask_b32 v56, 0, v24, s[38:39]
    v_cndmask_b32 v57, 0, v25, s[38:39]
    v_mfma_f32_16x16x32_bf16 v[148:151], v[84:87], v[36:39], v[148:151]
    v_cndmask_b32 v58, 0, v26, s[38:39]
    v_cndmask_b32 v59, 0, v27, s[38:39]
    v_mfma_f32_16x16x32_bf16 v[148:151], v[88:91], v[40:43], v[148:151]
    v_cndmask_b32 v60, 0, v28, s[38:39]
    v_cndmask_b32 v61, 0, v29, s[38:39]
    v_mfma_f32_16x16x32_bf16 v[148:151], v[92:95], v[44:47], v[148:151]
    v_cndmask_b32 v62, 0, v30, s[38:39]
    v_cndmask_b32 v63, 0, v31, s[38:39]
    ds_read_b128 v[80:83], v8 offset:4096
    ds_read_b128 v[84:87], v9 offset:4096
    ds_read_b128 v[88:91], v10 offset:4096
    ds_read_b128 v[92:95], v11 offset:4096
    s_waitcnt lgkmcnt(4)
    v_mfma_f32_16x16x32_bf16 v[152:155], v[64:67], v[32:35], 0
    v_mfma_f32_16x16x32_bf16 v[152:155], v[68:71], v[36:39], v[152:155]
    v_mfma_f32_16x16x32_bf16 v[152:155], v[72:75], v[40:43], v[152:155]
    v_mfma_f32_16x16x32_bf16 v[152:155], v[76:79], v[44:47], v[152:155]
    ds_read_b128 v[64:67], v8 offset:20480
    ds_read_b128 v[68:71], v9 offset:20480
    ds_read_b128 v[72:75], v10 offset:20480
    ds_read_b128 v[76:79], v11 offset:20480
    s_waitcnt lgkmcnt(4)
    v_mfma_f32_16x16x32_bf16 v[144:147], v[80:83], v[48:51], v[144:147]
    v_cndmask_b32 v32, 0, v16, s[40:41]
    v_cndmask_b32 v33, 0, v17, s[40:41]
    v_mfma_f32_16x16x32_bf16 v[144:147], v[84:87], v[52:55], v[144:147]
    v_cndmask_b32 v34, 0, v18, s[40:41]
    v_cndmask_b32 v35, 0, v19, s[40:41]
    v_mfma_f32_16x16x32_bf16 v[144:147], v[88:91], v[56:59], v[144:147]
    v_cndmask_b32 v36, 0, v20, s[40:41]
    v_cndmask_b32 v37, 0, v21, s[40:41]
    v_mfma_f32_16x16x32_bf16 v[144:147], v[92:95], v[60:63], v[144:147]
    v_cndmask_b32 v38, 0, v22, s[40:41]
    v_cndmask_b32 v39, 0, v23, s[40:41]
    ds_read_b128 v[80:83], v8 offset:8192
    ds_read_b128 v[84:87], v9 offset:8192
    ds_read_b128 v[88:91], v10 offset:8192
    ds_read_b128 v[92:95], v11 offset:8192
    s_waitcnt lgkmcnt(4)
    v_mfma_f32_16x16x32_bf16 v[148:151], v[64:67], v[48:51], v[148:151]
    v_cndmask_b32 v40, 0, v24, s[40:41]
    v_cndmask_b32 v41, 0, v25, s[40:41]
    v_mfma_f32_16x16x32_bf16 v[148:151], v[68:71], v[52:55], v[148:151]
    v_cndmask_b32 v42, 0, v26, s[40:41]
    v_cndmask_b32 v43, 0, v27, s[40:41]
    v_mfma_f32_16x16x32_bf16 v[148:151], v[72:75], v[56:59], v[148:151]
    v_cndmask_b32 v44, 0, v28, s[40:41]
    v_cndmask_b32 v45, 0, v29, s[40:41]
    v_mfma_f32_16x16x32_bf16 v[148:151], v[76:79], v[60:63], v[148:151]
    v_cndmask_b32 v46, 0, v30, s[40:41]
    v_cndmask_b32 v47, 0, v31, s[40:41]
    v_mfma_f32_16x16x32_bf16 v[152:155], v[96:99], v[48:51], v[152:155]
    v_mfma_f32_16x16x32_bf16 v[152:155], v[100:103], v[52:55], v[152:155]
    v_mfma_f32_16x16x32_bf16 v[152:155], v[104:107], v[56:59], v[152:155]
    v_mfma_f32_16x16x32_bf16 v[152:155], v[108:111], v[60:63], v[152:155]
    ds_read_b128 v[64:67], v8 offset:24576
    ds_read_b128 v[68:71], v9 offset:24576
    ds_read_b128 v[72:75], v10 offset:24576
    ds_read_b128 v[76:79], v11 offset:24576
    s_waitcnt lgkmcnt(4)
    v_mfma_f32_16x16x32_bf16 v[144:147], v[80:83], v[32:35], v[144:147]
    v_cndmask_b32 v48, 0, v16, s[42:43]
    v_cndmask_b32 v49, 0, v17, s[42:43]
    v_mfma_f32_16x16x32_bf16 v[144:147], v[84:87], v[36:39], v[144:147]
    v_cndmask_b32 v50, 0, v18, s[42:43]
    v_cndmask_b32 v51, 0, v19, s[42:43]
    v_mfma_f32_16x16x32_bf16 v[144:147], v[88:91], v[40:43], v[144:147]
    v_cndmask_b32 v52, 0, v20, s[42:43]
    v_cndmask_b32 v53, 0, v21, s[42:43]
    v_mfma_f32_16x16x32_bf16 v[144:147], v[92:95], v[44:47], v[144:147]
    v_cndmask_b32 v54, 0, v22, s[42:43]
    v_cndmask_b32 v55, 0, v23, s[42:43]
    ds_read_b128 v[80:83], v8 offset:12288
    ds_read_b128 v[84:87], v9 offset:12288
    ds_read_b128 v[88:91], v10 offset:12288
    ds_read_b128 v[92:95], v11 offset:12288
    s_waitcnt lgkmcnt(4)
    v_mfma_f32_16x16x32_bf16 v[148:151], v[64:67], v[32:35], v[148:151]
    v_cndmask_b32 v56, 0, v24, s[42:43]
    v_cndmask_b32 v57, 0, v25, s[42:43]
    v_mfma_f32_16x16x32_bf16 v[148:151], v[68:71], v[36:39], v[148:151]
    v_cndmask_b32 v58, 0, v26, s[42:43]
    v_cndmask_b32 v59, 0, v27, s[42:43]
    v_mfma_f32_16x16x32_bf16 v[148:151], v[72:75], v[40:43], v[148:151]
    v_cndmask_b32 v60, 0, v28, s[42:43]
    v_cndmask_b32 v61, 0, v29, s[42:43]
    v_mfma_f32_16x16x32_bf16 v[148:151], v[76:79], v[44:47], v[148:151]
    v_cndmask_b32 v62, 0, v30, s[42:43]
    v_cndmask_b32 v63, 0, v31, s[42:43]
    v_mfma_f32_16x16x32_bf16 v[152:155], v[112:115], v[32:35], v[152:155]
    v_mfma_f32_16x16x32_bf16 v[152:155], v[116:119], v[36:39], v[152:155]
    v_mfma_f32_16x16x32_bf16 v[152:155], v[120:123], v[40:43], v[152:155]
    v_mfma_f32_16x16x32_bf16 v[152:155], v[124:127], v[44:47], v[152:155]
    ds_read_b128 v[64:67], v8 offset:28672
    ds_read_b128 v[68:71], v9 offset:28672
    ds_read_b128 v[72:75], v10 offset:28672
    ds_read_b128 v[76:79], v11 offset:28672
    s_waitcnt lgkmcnt(4)
    v_mfma_f32_16x16x32_bf16 v[144:147], v[80:83], v[48:51], v[144:147]
    v_mfma_f32_16x16x32_bf16 v[144:147], v[84:87], v[52:55], v[144:147]
    v_mfma_f32_16x16x32_bf16 v[144:147], v[88:91], v[56:59], v[144:147]
    v_mfma_f32_16x16x32_bf16 v[144:147], v[92:95], v[60:63], v[144:147]
    s_waitcnt lgkmcnt(0)
    v_mfma_f32_16x16x32_bf16 v[148:151], v[64:67], v[48:51], v[148:151]
    v_mfma_f32_16x16x32_bf16 v[148:151], v[68:71], v[52:55], v[148:151]
    v_mfma_f32_16x16x32_bf16 v[148:151], v[72:75], v[56:59], v[148:151]
    v_mfma_f32_16x16x32_bf16 v[148:151], v[76:79], v[60:63], v[148:151]
    v_mfma_f32_16x16x32_bf16 v[152:155], v[128:131], v[48:51], v[152:155]
    v_mfma_f32_16x16x32_bf16 v[152:155], v[132:135], v[52:55], v[152:155]
    v_mfma_f32_16x16x32_bf16 v[152:155], v[136:139], v[56:59], v[152:155]
    v_mfma_f32_16x16x32_bf16 v[152:155], v[140:143], v[60:63], v[152:155]
    v_mov_b32 v160, 0xff800000
    v_cmp_lt_i32 vcc, 0, v161
    s_nop 1
    v_cndmask_b32 v148, v160, v148, vcc
    v_cmp_lt_i32 vcc, 4, v161
    s_nop 1
    v_cndmask_b32 v149, v160, v149, vcc
    v_cmp_lt_i32 vcc, 8, v161
    s_nop 1
    v_cndmask_b32 v150, v160, v150, vcc
    v_cmp_lt_i32 vcc, 12, v161
    s_nop 1
    v_cndmask_b32 v151, v160, v151, vcc
    v_cmp_lt_i32 vcc, 0, v163
    s_nop 1
    v_cndmask_b32 v152, v160, v152, vcc
    v_cmp_lt_i32 vcc, 4, v163
    s_nop 1
    v_cndmask_b32 v153, v160, v153, vcc
    v_cmp_lt_i32 vcc, 8, v163
    s_nop 1
    v_cndmask_b32 v154, v160, v154, vcc
    v_cmp_lt_i32 vcc, 12, v163
    s_nop 1
    v_cndmask_b32 v155, v160, v155, vcc
    v_max3_f32 v156, v144, v145, v146
    v_max3_f32 v157, v147, v148, v149
    v_max3_f32 v158, v150, v151, v152
    v_max3_f32 v159, v153, v154, v155
    v_max3_f32 v156, v156, v157, v158
    v_max_f32 v156, v156, v159
    s_nop 1
    v_max_f32_dpp v156, v156, v156 row_ror:4 row_mask:0xf bank_mask:0xf
    s_nop 1
    v_max_f32_dpp v156, v156, v156 row_ror:8 row_mask:0xf bank_mask:0xf
    v_mov_b32 v157, v156
    s_nop 1
    v_permlane16_swap_b32 v156, v157
    v_max_f32 v156, v156, v157
    v_mov_b32 v157, v156
    s_nop 1
    v_permlane32_swap_b32 v156, v157
    v_max_f32 v156, v156, v157
    s_mov_b32 s6, 0x3e0293ee
    v_mul_f32 v158, s6, v156
    v_fma_f32 v144, v144, s6, -v158
    v_fma_f32 v145, v145, s6, -v158
    v_fma_f32 v146, v146, s6, -v158
    v_fma_f32 v147, v147, s6, -v158
    v_fma_f32 v148, v148, s6, -v158
    v_fma_f32 v149, v149, s6, -v158
    v_fma_f32 v150, v150, s6, -v158
    v_fma_f32 v151, v151, s6, -v158
    v_fma_f32 v152, v152, s6, -v158
    v_fma_f32 v153, v153, s6, -v158
    v_fma_f32 v154, v154, s6, -v158
    v_fma_f32 v155, v155, s6, -v158
    v_exp_f32 v144, v144
    v_exp_f32 v145, v145
    v_exp_f32 v146, v146
    v_exp_f32 v147, v147
    v_exp_f32 v148, v148
    v_exp_f32 v149, v149
    v_exp_f32 v150, v150
    v_exp_f32 v151, v151
    v_exp_f32 v152, v152
    v_exp_f32 v153, v153
    v_exp_f32 v154, v154
    v_exp_f32 v155, v155
    v_cvt_pk_bf16_f32 v32, v144, v145
    v_cvt_pk_bf16_f32 v33, v146, v147
    ds_write_b64 v13, v[32:33] offset:0
    v_cvt_pk_bf16_f32 v34, v148, v149
    v_cvt_pk_bf16_f32 v35, v150, v151
    ds_write_b64 v13, v[34:35] offset:512
    v_cvt_pk_bf16_f32 v36, v152, v153
    v_cvt_pk_bf16_f32 v37, v154, v155
    ds_write_b64 v13, v[36:37] offset:1024
    v_add_f32 v159, v144, v145
    v_add_f32 v159, v159, v146
    v_add_f32 v159, v159, v147
    v_add_f32 v159, v159, v148
    v_add_f32 v159, v159, v149
    v_add_f32 v159, v159, v150
    v_add_f32 v159, v159, v151
    v_add_f32 v159, v159, v152
    v_add_f32 v159, v159, v153
    v_add_f32 v159, v159, v154
    v_add_f32 v159, v159, v155
    s_nop 1
    v_add_f32_dpp v159, v159, v159 row_ror:4 row_mask:0xf bank_mask:0xf
    s_nop 1
    v_add_f32_dpp v159, v159, v159 row_ror:8 row_mask:0xf bank_mask:0xf
    v_mov_b32 v157, v159
    s_nop 1
    v_permlane16_swap_b32 v159, v157
    v_add_f32 v159, v159, v157
    v_mov_b32 v157, v159
    s_nop 1
    v_permlane32_swap_b32 v159, v157
    v_add_f32 v159, v159, v157
    s_lshl_b32 s6, s4, 5
    s_add_u32 s6, s6, 154176
    v_lshl_add_u32 v14, v1, 3, s6
    s_mov_b64 exec, 15
    ds_write_b64 v14, v[158:159]
    s_mov_b64 exec, -1
    s_waitcnt lgkmcnt(0)
    v_mov_b32 v14, 155392
    v_mov_b32 v16, 1
    s_mov_b64 exec, 1
    ds_add_u32 v14, v16 offset:4
    s_mov_b64 exec, -1
    v_mov_b32 v14, 155392
    s_mov_b32 s30, 0
L_ps_4:
    ds_read_b32 v16, v14 offset:4
    s_add_u32 s30, s30, 1
    s_waitcnt lgkmcnt(0)
    v_cmp_ne_u32 vcc, 4, v16
    s_cbranch_vccz L_pd_5
    s_sleep 1
    s_cmp_lt_u32 s30, 8000000
    s_cbranch_scc1 L_ps_4
L_pd_5:
    v_and_b32 v14, 3, v1
    v_lshlrev_b32 v14, 3, v14
    v_add_u32 v14, 154176, v14
    ds_read_b64 v[16:17], v14 offset:0
    ds_read_b64 v[18:19], v14 offset:32
    ds_read_b64 v[20:21], v14 offset:64
    ds_read_b64 v[22:23], v14 offset:96
    v_lshrrev_b32 v2, 2, v1
    v_lshrrev_b32 v3, 4, v1
    v_add_u32 v3, v3, v1
    v_and_b32 v3, 3, v3
    v_lshlrev_b32 v2, 5, v2
    v_lshl_add_u32 v2, v3, 3, v2
    s_lshl_b32 s6, s4, 9
    s_add_u32 s6, s6, 0
    v_add_u32 v2, s6, v2
    s_waitcnt lgkmcnt(0)
    v_max3_f32 v24, v16, v18, v20
    v_max_f32 v24, v24, v22
    v_sub_f32 v25, v16, v24
    v_sub_f32 v26, v18, v24
    v_sub_f32 v27, v20, v24
    v_sub_f32 v28, v22, v24
    v_exp_f32 v25, v25
    v_exp_f32 v26, v26
    v_exp_f32 v27, v27
    v_exp_f32 v28, v28
    v_mul_f32 v29, v25, v17
    v_fmac_f32 v29, v26, v19
    v_fmac_f32 v29, v27, v21
    v_fmac_f32 v29, v28, v23
    v_log_f32 v30, v29
    v_rcp_f32 v29, v29
    v_mov_b32 v31, s33
    v_add_f32 v30, v30, v24
    s_lshl_b32 s6, s24, 11
    s_lshl_b32 s7, s25, 7
    s_add_u32 s6, s6, s7
    s_add_u32 s6, s6, 589824
    v_lshlrev_b32 v3, 3, v1
    s_cmp_eq_u32 s4, 0
    s_cselect_b32 exec_lo, 0xffff, 0
    s_mov_b32 exec_hi, 0
    s_cbranch_execz L_nlse
    buffer_store_dwordx2 v[30:31], v3, s[16:19], s6 offen sc1
L_nlse:
    s_mov_b64 exec, -1
    v_mul_f32 v32, v25, v29
    v_mul_f32 v33, v26, v29
    v_mul_f32 v34, v27, v29
    v_mul_f32 v35, v28, v29
    v_readlane_b32 s36, v32, s4
    v_readlane_b32 s37, v33, s4
    v_readlane_b32 s38, v34, s4
    v_readlane_b32 s39, v35, s4
L_xs:
    v_lshlrev_b32 v3, 2, v1
    s_barrier
    ds_read_b64 v[48:49], v2 offset:0
    ds_read_b64 v[50:51], v2 offset:2048
    ds_read_b64 v[52:53], v2 offset:4096
    ds_read_b64 v[54:55], v2 offset:6144
    ds_read_b64 v[56:57], v2 offset:8192
    ds_read_b64 v[58:59], v2 offset:10240
    ds_read_b64 v[60:61], v2 offset:12288
    ds_read_b64 v[62:63], v2 offset:14336
    s_waitcnt lgkmcnt(7)
    v_pk_mul_f32 v[40:41], v[48:49], s[36:37] op_sel_hi:[1,0]
    s_waitcnt lgkmcnt(6)
    v_pk_mul_f32 v[42:43], v[50:51], s[36:37] op_sel_hi:[1,0]
    s_waitcnt lgkmcnt(5)
    v_pk_fma_f32 v[40:41], v[52:53], s[36:37], v[40:41] op_sel:[0,1,0] op_sel_hi:[1,1,1]
    s_waitcnt lgkmcnt(4)
    v_pk_fma_f32 v[42:43], v[54:55], s[36:37], v[42:43] op_sel:[0,1,0] op_sel_hi:[1,1,1]
    s_waitcnt lgkmcnt(3)
    v_pk_fma_f32 v[40:41], v[56:57], s[38:39], v[40:41] op_sel_hi:[1,0,1]
    s_waitcnt lgkmcnt(2)
    v_pk_fma_f32 v[42:43], v[58:59], s[38:39], v[42:43] op_sel_hi:[1,0,1]
    s_waitcnt lgkmcnt(1)
    v_pk_fma_f32 v[40:41], v[60:61], s[38:39], v[40:41] op_sel:[0,1,0] op_sel_hi:[1,1,1]
    s_waitcnt lgkmcnt(0)
    v_pk_fma_f32 v[42:43], v[62:63], s[38:39], v[42:43] op_sel:[0,1,0] op_sel_hi:[1,1,1]
    s_nop 0
    v_pk_add_f32 v[40:41], v[40:41], v[42:43]
    v_cvt_pk_bf16_f32 v40, v40, v41
    buffer_store_dword v40, v3, s[16:19], s26 offen sc1
    s_endpgm
L_vwave:
    s_lshl_b32 s22, s31, 8
    s_sub_u32 s4, s4, 4
    v_lshlrev_b32 v2, 4, v1
    v_mov_b32 v16, 0
    v_mov_b32 v17, 0
    v_mov_b32 v18, 0
    v_mov_b32 v19, 0
    v_add_u32 v9, 153600, v2
    s_mov_b32 exec_lo, -1
    s_mov_b32 exec_hi, 3
    ds_write_b128 v9, v[16:19]
    s_mov_b64 exec, -1
    v_mov_b32 v9, 155392
    ds_write_b64 v9, v[16:17]
    s_mul_i32 s7, s4, 768
    s_add_u32 s7, s7, 147456
    v_and_b32 v9, 3, v1
    v_lshlrev_b32 v9, 6, v9
    v_lshrrev_b32 v10, 4, v1
    v_lshl_add_u32 v9, v10, 4, v9
    v_add_u32 v9, s7, v9
    v_mov_b32 v11, 153600
    s_mov_b32 s34, 0xf000f
    s_mov_b32 s35, s34
    v_cndmask_b32 v3, v11, v9, s[34:35]
    s_mov_b32 s34, 0xf000f0
    s_mov_b32 s35, s34
    v_cndmask_b32 v4, v11, v9, s[34:35]
    s_mov_b32 s34, 0xf000f00
    s_mov_b32 s35, s34
    v_cndmask_b32 v5, v11, v9, s[34:35]
    s_mov_b32 s34, 0xf000f000
    s_mov_b32 s35, s34
    v_cndmask_b32 v6, v11, v9, s[34:35]
    v_and_b32 v7, 15, v1
    v_lshrrev_b32 v8, 2, v7
    v_add_u32 v8, v8, v10
    v_and_b32 v8, 3, v8
    v_lshlrev_b32 v7, 5, v7
    v_lshl_add_u32 v7, v8, 3, v7
    s_lshl_b32 s7, s4, 11
    s_add_u32 s7, s7, 0
    v_add_u32 v7, s7, v7
    v_add_u32 v8, 1024, v7
    s_mov_b32 s36, 0x05040100
    s_mov_b32 s37, 0x07060302
    s_mul_i32 s27, s4, 22016
    s_add_u32 s7, s27, 22016
    s_min_u32 s22, s22, s7
    s_waitcnt lgkmcnt(0)
    s_add_u32 s20, s10, s6
    s_addc_u32 s21, s11, 0
    s_barrier
    buffer_load_dwordx4 v[72:75], v2, s[20:23], s27 offen offset:0 nt
    buffer_load_dwordx4 v[76:79], v2, s[20:23], s27 offen offset:1024 nt
    buffer_load_dwordx4 v[80:83], v2, s[20:23], s27 offen offset:2048 nt
    buffer_load_dwordx4 v[84:87], v2, s[20:23], s27 offen offset:3072 nt
    s_add_u32 s27, s27, 4096
    buffer_load_dwordx4 v[88:91], v2, s[20:23], s27 offen offset:0 nt
    buffer_load_dwordx4 v[92:95], v2, s[20:23], s27 offen offset:1024 nt
    buffer_load_dwordx4 v[96:99], v2, s[20:23], s27 offen offset:2048 nt
    buffer_load_dwordx4 v[100:103], v2, s[20:23], s27 offen offset:3072 nt
    s_add_u32 s27, s27, 4096
    buffer_load_dwordx4 v[104:107], v2, s[20:23], s27 offen offset:0 nt
    buffer_load_dwordx4 v[108:111], v2, s[20:23], s27 offen offset:1024 nt
    buffer_load_dwordx4 v[112:115], v2, s[20:23], s27 offen offset:2048 nt
    buffer_load_dwordx4 v[116:119], v2, s[20:23], s27 offen offset:3072 nt
    s_add_u32 s27, s27, 4096
    buffer_load_dwordx4 v[120:123], v2, s[20:23], s27 offen offset:0 nt
    buffer_load_dwordx4 v[124:127], v2, s[20:23], s27 offen offset:1024 nt
    buffer_load_dwordx4 v[128:131], v2, s[20:23], s27 offen offset:2048 nt
    buffer_load_dwordx4 v[132:135], v2, s[20:23], s27 offen offset:3072 nt
    s_add_u32 s27, s27, 4096
    buffer_load_dwordx4 v[136:139], v2, s[20:23], s27 offen offset:0 nt
    buffer_load_dwordx4 v[140:143], v2, s[20:23], s27 offen offset:1024 nt
    buffer_load_dwordx4 v[144:147], v2, s[20:23], s27 offen offset:2048 nt
    buffer_load_dwordx4 v[148:151], v2, s[20:23], s27 offen offset:3072 nt
    s_add_u32 s27, s27, 4096
    buffer_load_dwordx4 v[152:155], v2, s[20:23], s27 offen offset:0 nt
    buffer_load_dwordx4 v[156:159], v2, s[20:23], s27 offen offset:1024 nt
    buffer_load_dwordx4 v[160:163], v2, s[20:23], s27 offen offset:2048 nt
    buffer_load_dwordx4 v[164:167], v2, s[20:23], s27 offen offset:3072 nt
    v_mov_b32 v9, 155392
    s_mov_b32 s30, 0
L_ps_6:
    ds_read_b32 v10, v9 offset:4
    s_add_u32 s30, s30, 1
    s_waitcnt lgkmcnt(0)
    v_cmp_ne_u32 vcc, 4, v10
    s_cbranch_vccz L_pd_7
    s_sleep 1
    s_cmp_lt_u32 s30, 8000000
    s_cbranch_scc1 L_ps_6
L_pd_7:
    ds_read_b128 v[40:43], v3 offset:0
    ds_read_b128 v[44:47], v4 offset:0
    ds_read_b128 v[48:51], v5 offset:0
    ds_read_b128 v[52:55], v6 offset:0
    ds_read_b128 v[56:59], v3 offset:256
    ds_read_b128 v[60:63], v4 offset:256
    ds_read_b128 v[64:67], v5 offset:256
    ds_read_b128 v[68:71], v6 offset:256
    s_waitcnt vmcnt(16)
    v_perm_b32 v24, v76, v72, s36
    v_perm_b32 v25, v84, v80, s36
    v_perm_b32 v26, v92, v88, s36
    v_perm_b32 v27, v100, v96, s36
    s_waitcnt lgkmcnt(4)
    v_perm_b32 v28, v76, v72, s37
    v_perm_b32 v29, v84, v80, s37
    v_perm_b32 v30, v92, v88, s37
    v_perm_b32 v31, v100, v96, s37
    v_mfma_f32_16x16x32_bf16 v[16:19], v[40:43], v[24:27], 0
    v_perm_b32 v32, v77, v73, s36
    v_perm_b32 v33, v85, v81, s36
    v_perm_b32 v34, v93, v89, s36
    v_perm_b32 v35, v101, v97, s36
    v_mfma_f32_16x16x32_bf16 v[20:23], v[40:43], v[28:31], 0
    v_perm_b32 v36, v77, v73, s37
    v_perm_b32 v37, v85, v81, s37
    v_perm_b32 v38, v93, v89, s37
    v_perm_b32 v39, v101, v97, s37
    v_mfma_f32_16x16x32_bf16 v[16:19], v[44:47], v[32:35], v[16:19]
    v_perm_b32 v24, v78, v74, s36
    v_perm_b32 v25, v86, v82, s36
    v_perm_b32 v26, v94, v90, s36
    v_perm_b32 v27, v102, v98, s36
    v_mfma_f32_16x16x32_bf16 v[20:23], v[44:47], v[36:39], v[20:23]
    v_perm_b32 v28, v78, v74, s37
    v_perm_b32 v29, v86, v82, s37
    v_perm_b32 v30, v94, v90, s37
    v_perm_b32 v31, v102, v98, s37
    v_mfma_f32_16x16x32_bf16 v[16:19], v[48:51], v[24:27], v[16:19]
    v_perm_b32 v32, v79, v75, s36
    v_perm_b32 v33, v87, v83, s36
    v_perm_b32 v34, v95, v91, s36
    v_perm_b32 v35, v103, v99, s36
    v_mfma_f32_16x16x32_bf16 v[20:23], v[48:51], v[28:31], v[20:23]
    v_perm_b32 v36, v79, v75, s37
    v_perm_b32 v37, v87, v83, s37
    v_perm_b32 v38, v95, v91, s37
    v_perm_b32 v39, v103, v99, s37
    v_mfma_f32_16x16x32_bf16 v[16:19], v[52:55], v[32:35], v[16:19]
    s_nop 0
    v_mfma_f32_16x16x32_bf16 v[20:23], v[52:55], v[36:39], v[20:23]
    ds_read_b128 v[40:43], v3 offset:512
    ds_read_b128 v[44:47], v4 offset:512
    ds_read_b128 v[48:51], v5 offset:512
    ds_read_b128 v[52:55], v6 offset:512
    s_waitcnt vmcnt(8)
    v_perm_b32 v24, v108, v104, s36
    v_perm_b32 v25, v116, v112, s36
    v_perm_b32 v26, v124, v120, s36
    v_perm_b32 v27, v132, v128, s36
    s_waitcnt lgkmcnt(0)
    v_perm_b32 v28, v108, v104, s37
    v_perm_b32 v29, v116, v112, s37
    v_perm_b32 v30, v124, v120, s37
    v_perm_b32 v31, v132, v128, s37
    v_mfma_f32_16x16x32_bf16 v[16:19], v[56:59], v[24:27], v[16:19]
    v_perm_b32 v32, v109, v105, s36
    v_perm_b32 v33, v117, v113, s36
    v_perm_b32 v34, v125, v121, s36
    v_perm_b32 v35, v133, v129, s36
    v_mfma_f32_16x16x32_bf16 v[20:23], v[56:59], v[28:31], v[20:23]
    v_perm_b32 v36, v109, v105, s37
    v_perm_b32 v37, v117, v113, s37
    v_perm_b32 v38, v125, v121, s37
    v_perm_b32 v39, v133, v129, s37
    v_mfma_f32_16x16x32_bf16 v[16:19], v[60:63], v[32:35], v[16:19]
    v_perm_b32 v24, v110, v106, s36
    v_perm_b32 v25, v118, v114, s36
    v_perm_b32 v26, v126, v122, s36
    v_perm_b32 v27, v134, v130, s36
    v_mfma_f32_16x16x32_bf16 v[20:23], v[60:63], v[36:39], v[20:23]
    v_perm_b32 v28, v110, v106, s37
    v_perm_b32 v29, v118, v114, s37
    v_perm_b32 v30, v126, v122, s37
    v_perm_b32 v31, v134, v130, s37
    v_mfma_f32_16x16x32_bf16 v[16:19], v[64:67], v[24:27], v[16:19]
    v_perm_b32 v32, v111, v107, s36
    v_perm_b32 v33, v119, v115, s36
    v_perm_b32 v34, v127, v123, s36
    v_perm_b32 v35, v135, v131, s36
    v_mfma_f32_16x16x32_bf16 v[20:23], v[64:67], v[28:31], v[20:23]
    v_perm_b32 v36, v111, v107, s37
    v_perm_b32 v37, v119, v115, s37
    v_perm_b32 v38, v127, v123, s37
    v_perm_b32 v39, v135, v131, s37
    v_mfma_f32_16x16x32_bf16 v[16:19], v[68:71], v[32:35], v[16:19]
    s_nop 0
    v_mfma_f32_16x16x32_bf16 v[20:23], v[68:71], v[36:39], v[20:23]
    s_waitcnt vmcnt(0)
    v_perm_b32 v24, v140, v136, s36
    v_perm_b32 v25, v148, v144, s36
    v_perm_b32 v26, v156, v152, s36
    v_perm_b32 v27, v164, v160, s36
    s_waitcnt lgkmcnt(0)
    v_perm_b32 v28, v140, v136, s37
    v_perm_b32 v29, v148, v144, s37
    v_perm_b32 v30, v156, v152, s37
    v_perm_b32 v31, v164, v160, s37
    v_mfma_f32_16x16x32_bf16 v[16:19], v[40:43], v[24:27], v[16:19]
    v_perm_b32 v32, v141, v137, s36
    v_perm_b32 v33, v149, v145, s36
    v_perm_b32 v34, v157, v153, s36
    v_perm_b32 v35, v165, v161, s36
    v_mfma_f32_16x16x32_bf16 v[20:23], v[40:43], v[28:31], v[20:23]
    v_perm_b32 v36, v141, v137, s37
    v_perm_b32 v37, v149, v145, s37
    v_perm_b32 v38, v157, v153, s37
    v_perm_b32 v39, v165, v161, s37
    v_mfma_f32_16x16x32_bf16 v[16:19], v[44:47], v[32:35], v[16:19]
    v_perm_b32 v24, v142, v138, s36
    v_perm_b32 v25, v150, v146, s36
    v_perm_b32 v26, v158, v154, s36
    v_perm_b32 v27, v166, v162, s36
    v_mfma_f32_16x16x32_bf16 v[20:23], v[44:47], v[36:39], v[20:23]
    v_perm_b32 v28, v142, v138, s37
    v_perm_b32 v29, v150, v146, s37
    v_perm_b32 v30, v158, v154, s37
    v_perm_b32 v31, v166, v162, s37
    v_mfma_f32_16x16x32_bf16 v[16:19], v[48:51], v[24:27], v[16:19]
    v_perm_b32 v32, v143, v139, s36
    v_perm_b32 v33, v151, v147, s36
    v_perm_b32 v34, v159, v155, s36
    v_perm_b32 v35, v167, v163, s36
    v_mfma_f32_16x16x32_bf16 v[20:23], v[48:51], v[28:31], v[20:23]
    v_perm_b32 v36, v143, v139, s37
    v_perm_b32 v37, v151, v147, s37
    v_perm_b32 v38, v159, v155, s37
    v_perm_b32 v39, v167, v163, s37
    v_mfma_f32_16x16x32_bf16 v[16:19], v[52:55], v[32:35], v[16:19]
    s_nop 0
    v_mfma_f32_16x16x32_bf16 v[20:23], v[52:55], v[36:39], v[20:23]
    s_nop 7
    ds_write2_b32 v7, v16, v20 offset0:0 offset1:1
    ds_write2_b32 v7, v17, v21 offset0:128 offset1:129
    ds_write2_b32 v8, v18, v22 offset0:0 offset1:1
    ds_write2_b32 v8, v19, v23 offset0:128 offset1:129
    s_waitcnt lgkmcnt(0)
L_xv:
    s_barrier
    s_endpgm
L_spare:
    s_cmp_lg_u32 s5, 0
    s_cbranch_scc1 L_end
    s_cmp_lg_u32 s4, 8
    s_cbranch_scc1 L_end
    v_mov_b32 v4, -1
    v_mov_b32 v5, -1
    v_mov_b32 v6, -1
    v_mov_b32 v7, -1
    s_lshl_b32 s6, s3, 10
    s_add_u32 s6, s6, 114688
    v_lshlrev_b32 v2, 4, v1
    v_add_u32 v2, s6, v2
    s_lshl_b32 s6, s3, 11
    s_add_u32 s6, s6, 147456
    v_lshlrev_b32 v8, 4, v1
    v_add_u32 v8, s6, v8
    s_waitcnt lgkmcnt(0)
    global_store_dwordx4 v2, v[4:7], s[14:15] sc1
    s_cmp_ge_u32 s3, 28
    s_cbranch_scc1 L_sp2
    global_store_dwordx4 v8, v[4:7], s[14:15] offset:0 sc1
    global_store_dwordx4 v8, v[4:7], s[14:15] offset:1024 sc1
L_sp2:
    s_waitcnt vmcnt(0)
    s_endpgm
L_helper:
    s_load_dword s33, s[14:15], 108544
    s_load_dwordx2 s[44:45], s[0:1], 0
    s_load_dwordx4 s[48:51], s[0:1], 24
    s_load_dwordx4 s[52:55], s[0:1], 80
    v_lshrrev_b32 v10, 3, v1
    v_and_b32 v11, 3, v1
    v_lshlrev_b32 v11, 1, v11
    v_lshl_add_u32 v10, v10, 3, v11
    v_bfe_u32 v11, v1, 2, 1
    s_lshl_b32 s6, s4, 6
    v_add_u32 v12, s6, v10
    v_lshlrev_b32 v6, 1, v12
    v_lshl_add_u32 v6, v11, 10, v6
    v_lshlrev_b32 v9, 2, v12
    v_lshl_add_u32 v9, v11, 11, v9
    v_add_u32 v9, 145664, v9
    s_lshr_b32 s6, s4, 2
    s_mul_i32 s6, s6, 576
    s_and_b32 s7, s4, 3
    s_lshl_b32 s7, s7, 7
    s_add_u32 s6, s6, s7
    s_add_u32 s6, s6, 131072
    v_mul_u32_u24 v7, 1152, v11
    v_lshl_add_u32 v7, v10, 1, v7
    v_add_u32 v7, s6, v7
    v_lshrrev_b32 v13, 3, v1
    v_lshlrev_b32 v13, 2, v13
    v_lshl_add_u32 v13, v11, 5, v13
    v_add_u32 v13, 145408, v13
    s_waitcnt lgkmcnt(0)
    s_mov_b32 s16, s14
    s_mov_b32 s17, s15
    s_mov_b32 s18, 1048576
    s_mov_b32 s19, 0x20000
    s_mul_i32 s33, s33, 0x9E3779B1
    s_add_u32 s33, s33, 0x85EBCA6B
    global_load_dword v17, v6, s[52:53]
    global_load_dword v16, v6, s[44:45]
    s_cmp_eq_u32 s5, 0
    s_cbranch_scc1 L_t2
    s_add_u32 s24, s25, 128
    v_bfe_u32 v10, v1, 4, 1
    v_and_b32 v12, 7, v1
    v_xor_b32 v10, v10, v12
    s_and_b32 s27, s4, 4
    v_xor_b32 v10, s27, v10
    v_lshrrev_b32 v2, 3, v1
    v_mul_u32_u24 v2, 8192, v2
    v_xor_b32 v12, 2, v10
    v_lshl_add_u32 v12, v12, 4, v2
    v_lshl_add_u32 v2, v10, 4, v2
    s_mov_b32 s20, s48
    s_mov_b32 s21, s49
    s_mov_b32 s22, 4194304
    s_mov_b32 s23, 0x20000
    s_mul_i32 s27, s4, 524288
    s_add_u32 s27, s27, s24
    s_lshl_b32 s28, s4, 13
    s_add_u32 s28, s28, 65536
    s_mov_b32 m0, s28
    s_add_u32 s28, s28, 1024
    buffer_load_dwordx4 v2, s[20:23], s27 offen nt lds
    s_add_u32 s27, s27, 65536
    s_mov_b32 m0, s28
    s_add_u32 s28, s28, 1024
    buffer_load_dwordx4 v12, s[20:23], s27 offen nt lds
    s_add_u32 s27, s27, 65536
    s_mov_b32 m0, s28
    s_add_u32 s28, s28, 1024
    buffer_load_dwordx4 v2, s[20:23], s27 offen nt lds
    s_add_u32 s27, s27, 65536
    s_mov_b32 m0, s28
    s_add_u32 s28, s28, 1024
    buffer_load_dwordx4 v12, s[20:23], s27 offen nt lds
    s_add_u32 s27, s27, 65536
    s_mov_b32 m0, s28
    s_add_u32 s28, s28, 1024
    buffer_load_dwordx4 v2, s[20:23], s27 offen nt lds
    s_add_u32 s27, s27, 65536
    s_mov_b32 m0, s28
    s_add_u32 s28, s28, 1024
    buffer_load_dwordx4 v12, s[20:23], s27 offen nt lds
    s_add_u32 s27, s27, 65536
    s_mov_b32 m0, s28
    s_add_u32 s28, s28, 1024
    buffer_load_dwordx4 v2, s[20:23], s27 offen nt lds
    s_add_u32 s27, s27, 65536
    s_mov_b32 m0, s28
    s_nop 0
    buffer_load_dwordx4 v12, s[20:23], s27 offen nt lds
    s_branch L_h2
L_t2:
    s_lshr_b32 s26, s3, 1
    s_lshl_b32 s24, s26, 18
    s_and_b32 s6, s3, 1
    s_lshl_b32 s6, s6, 9
    s_add_u32 s24, s24, s6
    s_and_b32 s6, s4, 1
    s_lshl_b32 s6, s6, 6
    s_and_b32 s7, s4, 4
    s_lshl_b32 s7, s7, 5
    s_or_b32 s6, s6, s7
    v_lshlrev_b32 v2, 4, v1
    v_and_b32 v2, 0x1f0, v2
    v_and_b32 v10, 32, v1
    v_xor_b32 v2, v2, v10
    v_xor_b32 v2, s6, v2
    v_lshl_add_u32 v2, v10, 5, v2
    s_mov_b32 s20, s50
    s_mov_b32 s21, s51
    s_mov_b32 s22, 4194304
    s_mov_b32 s23, 0x20000
    s_lshl_b32 s27, s4, 11
    s_add_u32 s27, s27, s24
    s_add_u32 s27, s27, 131072
    s_lshl_b32 s28, s4, 10
    s_add_u32 s28, s28, 65536
    s_mov_b32 m0, s28
    s_add_u32 s28, s28, 8192
    buffer_load_dwordx4 v2, s[20:23], s27 offen nt lds
    s_add_u32 s27, s27, 16384
    s_mov_b32 m0, s28
    s_add_u32 s28, s28, 8192
    buffer_load_dwordx4 v2, s[20:23], s27 offen nt lds
    s_add_u32 s27, s27, 16384
    s_mov_b32 m0, s28
    s_nop 0
    buffer_load_dwordx4 v2, s[20:23], s27 offen nt lds
L_h2:
    v_lshrrev_b32 v10, 4, v1
    v_bfe_u32 v11, v1, 2, 2
    v_lshl_add_u32 v3, v10, 3, v11
    v_bfe_u32 v11, v1, 1, 1
    v_lshl_add_u32 v3, v11, 8, v3
    v_lshlrev_b32 v3, 7, v3
    v_bfe_u32 v12, v1, 3, 2
    v_lshl_add_u32 v12, v11, 2, v12
    v_xor_b32 v12, s4, v12
    v_lshl_add_u32 v3, v12, 4, v3
    v_and_b32 v12, 1, v1
    v_lshl_add_u32 v3, v12, 3, v3
    v_lshl_add_u32 v4, v12, 1, v11
    v_mul_u32_u24 v4, 576, v4
    v_lshl_add_u32 v4, v10, 4, v4
    v_add_u32 v4, 131072, v4
    v_lshlrev_b32 v5, 3, v0
    s_lshl_b32 s6, s4, 7
    v_lshl_add_u32 v8, v1, 3, s6
    v_lshlrev_b32 v28, 4, v0
    v_and_b32 v10, 0x37, v1
    v_cmp_eq_u32 vcc, 1, v10
    v_mov_b32 v18, 0x3727c5ac
    s_nop 0
    v_cndmask_b32 v18, 0, v18, vcc
    v_lshlrev_b32 v10, 2, v1
    v_add_u32 v10, 145408, v10
    v_mov_b32 v39, s33
    v_mov_b32 v37, s33
    s_mov_b32 exec_lo, -1
    s_mov_b32 exec_hi, 0xffff
    ds_write_b32 v10, v18
    s_mov_b64 exec, -1
    s_cmp_eq_u32 s5, 0
    s_cbranch_scc1 L_tail
    s_mov_b32 s60, 0
    s_mov_b32 s61, 8192
    s_mov_b32 s62, 16384
    s_mov_b32 s63, 24576
    buffer_load_dwordx4 v[136:139], v28, s[16:19], s60 offen sc1
    buffer_load_dwordx4 v[140:143], v28, s[16:19], s61 offen sc1
    buffer_load_dwordx4 v[144:147], v28, s[16:19], s62 offen sc1
    buffer_load_dwordx4 v[148:151], v28, s[16:19], s63 offen sc1
    s_waitcnt vmcnt(12)
    v_lshlrev_b32 v18, 16, v17
    v_and_b32 v19, 0xffff0000, v17
    s_mov_b32 s6, 0xbfb8aa3b
    v_mul_f32 v20, s6, v18
    v_mul_f32 v21, s6, v19
    v_exp_f32 v20, v20
    v_exp_f32 v21, v21
    v_add_f32 v20, 1.0, v20
    v_add_f32 v21, 1.0, v21
    v_rcp_f32 v20, v20
    v_rcp_f32 v21, v21
    v_mul_f32 v18, v18, v20
    v_mul_f32 v19, v19, v21
    v_cvt_pk_bf16_f32 v18, v18, v19
    ds_write_b32 v7, v18 offset:2304
    v_lshlrev_b32 v14, 16, v16
    v_and_b32 v15, 0xffff0000, v16
    v_add_f32 v18, v14, v15
    v_mul_f32 v19, v14, v14
    v_fmac_f32 v19, v15, v15
    s_waitcnt lgkmcnt(0)
    s_barrier
    v_add_f32_dpp v24, v18, v18 row_ror:8 row_mask:0xf bank_mask:0x3
    v_add_f32_dpp v25, v18, v18 row_ror:8 row_mask:0xf bank_mask:0x3
    v_add_f32_dpp v26, v18, v18 row_ror:8 row_mask:0xf bank_mask:0x3
    v_add_f32_dpp v24, v19, v19 row_ror:8 row_mask:0xf bank_mask:0xc
    v_add_f32_dpp v25, v19, v19 row_ror:8 row_mask:0xf bank_mask:0xc
    v_add_f32_dpp v26, v19, v19 row_ror:8 row_mask:0xf bank_mask:0xc
    s_nop 0
    v_permlane16_swap_b32 v24, v25
    v_permlane16_swap_b32 v26, v27
    v_add_f32 v24, v24, v25
    v_add_f32 v26, v26, v27
    s_nop 1
    v_permlane32_swap_b32 v24, v26
    v_add_f32 v24, v24, v26
    s_nop 1
    v_add_f32_dpp v24, v24, v24 quad_perm:[1,0,3,2] row_mask:0xf bank_mask:0xf
    s_nop 1
    v_add_f32_dpp v24, v24, v24 quad_perm:[2,3,0,1] row_mask:0xf bank_mask:0xf
    s_mov_b32 exec_lo, 0x11111111
    s_mov_b32 exec_hi, 0x1111
    ds_add_f32 v13, v24 offset:64
    s_mov_b64 exec, -1
    ds_read_b64_tr_b16 v[40:41], v3 offset:0
    ds_read_b64_tr_b16 v[42:43], v3 offset:512
    ds_read_b64_tr_b16 v[44:45], v3 offset:4096
    ds_read_b64_tr_b16 v[46:47], v3 offset:4608
    ds_read_b64_tr_b16 v[48:49], v3 offset:8192
    ds_read_b64_tr_b16 v[50:51], v3 offset:8704
    ds_read_b64_tr_b16 v[52:53], v3 offset:12288
    ds_read_b64_tr_b16 v[54:55], v3 offset:12800
    ds_read_b64_tr_b16 v[56:57], v3 offset:16384
    ds_read_b64_tr_b16 v[58:59], v3 offset:16896
    ds_read_b64_tr_b16 v[60:61], v3 offset:20480
    ds_read_b64_tr_b16 v[62:63], v3 offset:20992
    ds_read_b64_tr_b16 v[64:65], v3 offset:24576
    ds_read_b64_tr_b16 v[66:67], v3 offset:25088
    ds_read_b64_tr_b16 v[68:69], v3 offset:28672
    ds_read_b64_tr_b16 v[70:71], v3 offset:29184
    s_waitcnt lgkmcnt(0)
    s_barrier
    s_lshl_b32 s24, s3, 7
    s_add_u32 s24, s24, 2048
    v_bfe_u32 v10, v1, 2, 1
    v_lshlrev_b32 v10, 5, v10
    v_add_u32 v10, 145472, v10
    ds_read_b64 v[18:19], v10
    s_waitcnt lgkmcnt(0)
    s_mov_b32 s6, 0x3b000000
    s_mov_b32 s7, 0x3727c5ac
    v_mul_f32 v18, s6, v18
    v_mul_f32 v19, s6, v19
    v_fma_f32 v19, -v18, v18, v19
    v_max_f32 v19, 0, v19
    v_add_f32 v19, s7, v19
    v_rsq_f32 v19, v19
    v_sub_f32 v20, v14, v18
    v_sub_f32 v21, v15, v18
    v_mul_f32 v20, v20, v19
    v_mul_f32 v21, v21, v19
    v_bfe_u32 v30, v1, 1, 2
    v_lshlrev_b32 v30, 3, v30
    v_bfe_u32 v11, v1, 3, 1
    v_lshl_add_u32 v30, v11, 9, v30
    v_bfe_u32 v11, v1, 4, 1
    v_lshl_add_u32 v30, v11, 8, v30
    s_lshl_b32 s6, s4, 5
    s_add_u32 s6, s6, 145664
    v_add_u32 v30, s6, v30
    v_lshlrev_b32 v31, 4, v1
    v_add_u32 v29, 145664, v31
    v_lshrrev_b32 v11, 5, v1
    v_mul_u32_u24 v11, 1536, v11
    v_add_u32 v31, v31, v11
    s_mov_b32 s30, 0
    s_waitcnt vmcnt(0)
    s_branch L_vw_10
L_vp_8:
    buffer_load_dwordx4 v[136:139], v28, s[16:19], s60 offen sc1
    buffer_load_dwordx4 v[140:143], v28, s[16:19], s61 offen sc1
    buffer_load_dwordx4 v[144:147], v28, s[16:19], s62 offen sc1
    buffer_load_dwordx4 v[148:151], v28, s[16:19], s63 offen sc1
    s_add_u32 s30, s30, 1
    s_waitcnt vmcnt(0)
L_vw_10:
    v_max3_u32 v22, v137, v139, v141
    v_max3_u32 v22, v22, v143, v145
    v_max3_u32 v22, v22, v147, v149
    v_max_u32 v22, v22, v151
    v_min3_u32 v23, v137, v139, v141
    v_min3_u32 v23, v23, v143, v145
    v_min3_u32 v23, v23, v147, v149
    v_min_u32 v23, v23, v151
    v_cmp_ne_u32 vcc, s33, v22
    v_cmp_ne_u32 s[34:35], s33, v23
    s_nop 0
    s_or_b64 vcc, vcc, s[34:35]
    s_cbranch_vccz L_vd_9
    s_sleep 2
    s_cmp_lt_u32 s30, 1000000
    s_cbranch_scc1 L_vp_8
L_vd_9:
    v_add_f32 v22, v136, v144
    v_add_f32 v23, v138, v146
    v_add_f32 v24, v140, v148
    v_add_f32 v25, v142, v150
    v_add_f32 v24, 1.0, v24
    v_add_f32 v25, 1.0, v25
    v_fma_f32 v20, v20, v24, v22
    v_fma_f32 v21, v21, v25, v23
    v_cvt_pk_bf16_f32 v20, v20, v21
    ds_write_b32 v7, v20
    s_waitcnt lgkmcnt(0)
    s_barrier
    v_add_u32 v10, 65536, v3
    ds_read_b64_tr_b16 v[72:73], v10 offset:0
    ds_read_b64_tr_b16 v[74:75], v10 offset:512
    ds_read_b64_tr_b16 v[76:77], v10 offset:4096
    ds_read_b64_tr_b16 v[78:79], v10 offset:4608
    ds_read_b64_tr_b16 v[80:81], v10 offset:8192
    ds_read_b64_tr_b16 v[82:83], v10 offset:8704
    ds_read_b64_tr_b16 v[84:85], v10 offset:12288
    ds_read_b64_tr_b16 v[86:87], v10 offset:12800
    ds_read_b64_tr_b16 v[88:89], v10 offset:16384
    ds_read_b64_tr_b16 v[90:91], v10 offset:16896
    ds_read_b64_tr_b16 v[92:93], v10 offset:20480
    ds_read_b64_tr_b16 v[94:95], v10 offset:20992
    ds_read_b64_tr_b16 v[96:97], v10 offset:24576
    ds_read_b64_tr_b16 v[98:99], v10 offset:25088
    ds_read_b64_tr_b16 v[100:101], v10 offset:28672
    ds_read_b64_tr_b16 v[102:103], v10 offset:29184
    ds_read_b128 v[136:139], v4 offset:0
    ds_read_b128 v[140:143], v4 offset:64
    ds_read_b128 v[144:147], v4 offset:128
    ds_read_b128 v[148:151], v4 offset:192
    ds_read_b128 v[152:155], v4 offset:256
    ds_read_b128 v[156:159], v4 offset:320
    ds_read_b128 v[160:163], v4 offset:384
    ds_read_b128 v[164:167], v4 offset:448
    s_waitcnt lgkmcnt(7)
    v_mfma_f32_16x16x32_bf16 v[32:35], v[136:139], v[40:43], 0
    v_mfma_f32_16x16x32_bf16 v[24:27], v[136:139], v[72:75], 0
    s_waitcnt lgkmcnt(6)
    v_mfma_f32_16x16x32_bf16 v[32:35], v[140:143], v[44:47], v[32:35]
    v_mfma_f32_16x16x32_bf16 v[24:27], v[140:143], v[76:79], v[24:27]
    s_waitcnt lgkmcnt(5)
    v_mfma_f32_16x16x32_bf16 v[32:35], v[144:147], v[48:51], v[32:35]
    v_mfma_f32_16x16x32_bf16 v[24:27], v[144:147], v[80:83], v[24:27]
    s_waitcnt lgkmcnt(4)
    v_mfma_f32_16x16x32_bf16 v[32:35], v[148:151], v[52:55], v[32:35]
    v_mfma_f32_16x16x32_bf16 v[24:27], v[148:151], v[84:87], v[24:27]
    s_waitcnt lgkmcnt(3)
    v_mfma_f32_16x16x32_bf16 v[32:35], v[152:155], v[56:59], v[32:35]
    v_mfma_f32_16x16x32_bf16 v[24:27], v[152:155], v[88:91], v[24:27]
    s_waitcnt lgkmcnt(2)
    v_mfma_f32_16x16x32_bf16 v[32:35], v[156:159], v[60:63], v[32:35]
    v_mfma_f32_16x16x32_bf16 v[24:27], v[156:159], v[92:95], v[24:27]
    s_waitcnt lgkmcnt(1)
    v_mfma_f32_16x16x32_bf16 v[32:35], v[160:163], v[64:67], v[32:35]
    v_mfma_f32_16x16x32_bf16 v[24:27], v[160:163], v[96:99], v[24:27]
    s_waitcnt lgkmcnt(0)
    v_mfma_f32_16x16x32_bf16 v[32:35], v[164:167], v[68:71], v[32:35]
    v_mfma_f32_16x16x32_bf16 v[24:27], v[164:167], v[100:103], v[24:27]
    s_nop 6
    v_add_f32_dpp v36, v34, v32 row_ror:8 row_mask:0x1 bank_mask:0x3
    v_add_f32_dpp v36, v33, v35 row_ror:8 row_mask:0x1 bank_mask:0xc
    v_add_f32_dpp v36, v26, v24 row_ror:8 row_mask:0x2 bank_mask:0x3
    v_add_f32_dpp v36, v25, v27 row_ror:8 row_mask:0x2 bank_mask:0xc
    s_nop 1
    v_mov_b32_dpp v38, v36 quad_perm:[1,1,3,3] row_mask:0xf bank_mask:0xf
    s_mov_b64 exec, 0x55555555
    v_cvt_pk_bf16_f32 v38, v36, v38
    ds_write_b64 v30, v[38:39]
    s_mov_b64 exec, -1
    s_waitcnt lgkmcnt(0)
    s_barrier
    s_cmp_lg_u32 s4, 0
    s_cbranch_scc1 L_nqp
    s_lshr_b32 s6, s3, 2
    s_lshl_b32 s6, s6, 12
    s_and_b32 s7, s3, 3
    s_lshl_b32 s7, s7, 9
    s_add_u32 s6, s6, s7
    s_add_u32 s6, s6, 65536
    ds_read_b128 v[24:27], v29
    s_waitcnt lgkmcnt(0)
    buffer_store_dwordx4 v[24:27], v31, s[16:19], s6 offen sc1
L_nqp:
    v_bfe_u32 v10, v1, 4, 1
    v_and_b32 v12, 7, v1
    v_xor_b32 v10, v10, v12
    s_and_b32 s27, s4, 4
    v_xor_b32 v10, s27, v10
    v_lshrrev_b32 v2, 3, v1
    v_mul_u32_u24 v2, 6144, v2
    v_xor_b32 v12, 2, v10
    v_lshl_add_u32 v12, v12, 4, v2
    v_lshl_add_u32 v2, v10, 4, v2
    s_mov_b32 s20, s54
    s_mov_b32 s21, s55
    s_mov_b32 s22, 3145728
    s_mov_b32 s23, 0x20000
    s_mul_i32 s27, s4, 393216
    s_add_u32 s27, s27, s24
    s_lshl_b32 s28, s4, 13
    s_mov_b32 m0, s28
    s_add_u32 s28, s28, 1024
    buffer_load_dwordx4 v2, s[20:23], s27 offen nt lds
    s_add_u32 s27, s27, 49152
    s_mov_b32 m0, s28
    s_add_u32 s28, s28, 1024
    buffer_load_dwordx4 v12, s[20:23], s27 offen nt lds
    s_add_u32 s27, s27, 49152
    s_mov_b32 m0, s28
    s_add_u32 s28, s28, 1024
    buffer_load_dwordx4 v2, s[20:23], s27 offen nt lds
    s_add_u32 s27, s27, 49152
    s_mov_b32 m0, s28
    s_add_u32 s28, s28, 1024
    buffer_load_dwordx4 v12, s[20:23], s27 offen nt lds
    s_add_u32 s27, s27, 49152
    s_mov_b32 m0, s28
    s_add_u32 s28, s28, 1024
    buffer_load_dwordx4 v2, s[20:23], s27 offen nt lds
    s_add_u32 s27, s27, 49152
    s_mov_b32 m0, s28
    s_add_u32 s28, s28, 1024
    buffer_load_dwordx4 v12, s[20:23], s27 offen nt lds
    s_add_u32 s27, s27, 49152
    s_mov_b32 m0, s28
    s_add_u32 s28, s28, 1024
    buffer_load_dwordx4 v2, s[20:23], s27 offen nt lds
    s_add_u32 s27, s27, 49152
    s_mov_b32 m0, s28
    s_nop 0
    buffer_load_dwordx4 v12, s[20:23], s27 offen nt lds
    s_waitcnt vmcnt(0)
    s_barrier
    ds_read_b64_tr_b16 v[40:41], v3 offset:0
    ds_read_b64_tr_b16 v[42:43], v3 offset:512
    ds_read_b64_tr_b16 v[44:45], v3 offset:4096
    ds_read_b64_tr_b16 v[46:47], v3 offset:4608
    ds_read_b64_tr_b16 v[48:49], v3 offset:8192
    ds_read_b64_tr_b16 v[50:51], v3 offset:8704
    ds_read_b64_tr_b16 v[52:53], v3 offset:12288
    ds_read_b64_tr_b16 v[54:55], v3 offset:12800
    ds_read_b64_tr_b16 v[56:57], v3 offset:16384
    ds_read_b64_tr_b16 v[58:59], v3 offset:16896
    ds_read_b64_tr_b16 v[60:61], v3 offset:20480
    ds_read_b64_tr_b16 v[62:63], v3 offset:20992
    ds_read_b64_tr_b16 v[64:65], v3 offset:24576
    ds_read_b64_tr_b16 v[66:67], v3 offset:25088
    ds_read_b64_tr_b16 v[68:69], v3 offset:28672
    ds_read_b64_tr_b16 v[70:71], v3 offset:29184
    ds_read_b128 v[136:139], v4 offset:2304
    ds_read_b128 v[140:143], v4 offset:2368
    ds_read_b128 v[144:147], v4 offset:2432
    ds_read_b128 v[148:151], v4 offset:2496
    ds_read_b128 v[152:155], v4 offset:2560
    ds_read_b128 v[156:159], v4 offset:2624
    ds_read_b128 v[160:163], v4 offset:2688
    ds_read_b128 v[164:167], v4 offset:2752
    s_waitcnt lgkmcnt(7)
    v_mfma_f32_16x16x32_bf16 v[32:35], v[136:139], v[40:43], 0
    s_waitcnt lgkmcnt(6)
    v_mfma_f32_16x16x32_bf16 v[32:35], v[140:143], v[44:47], v[32:35]
    s_waitcnt lgkmcnt(5)
    v_mfma_f32_16x16x32_bf16 v[32:35], v[144:147], v[48:51], v[32:35]
    s_waitcnt lgkmcnt(4)
    v_mfma_f32_16x16x32_bf16 v[32:35], v[148:151], v[52:55], v[32:35]
    s_waitcnt lgkmcnt(3)
    v_mfma_f32_16x16x32_bf16 v[32:35], v[152:155], v[56:59], v[32:35]
    s_waitcnt lgkmcnt(2)
    v_mfma_f32_16x16x32_bf16 v[32:35], v[156:159], v[60:63], v[32:35]
    s_waitcnt lgkmcnt(1)
    v_mfma_f32_16x16x32_bf16 v[32:35], v[160:163], v[64:67], v[32:35]
    s_waitcnt lgkmcnt(0)
    v_mfma_f32_16x16x32_bf16 v[32:35], v[164:167], v[68:71], v[32:35]
    s_nop 7
    v_add_f32_dpp v36, v34, v32 row_ror:8 row_mask:0xf bank_mask:0x3
    v_add_f32_dpp v36, v33, v35 row_ror:8 row_mask:0xf bank_mask:0xc
    s_lshl_b32 s6, s3, 10
    s_add_u32 s6, s6, 32768
    s_mov_b64 exec, 0xffff
    buffer_store_dwordx2 v[36:37], v8, s[16:19], s6 offen sc1
    s_mov_b64 exec, -1
    s_endpgm
L_tail:
    s_waitcnt vmcnt(3)
    v_lshlrev_b32 v18, 16, v17
    v_and_b32 v19, 0xffff0000, v17
    s_mov_b32 s6, 0xbfb8aa3b
    v_mul_f32 v20, s6, v18
    v_mul_f32 v21, s6, v19
    v_exp_f32 v20, v20
    v_exp_f32 v21, v21
    v_add_f32 v20, 1.0, v20
    v_add_f32 v21, 1.0, v21
    v_rcp_f32 v20, v20
    v_rcp_f32 v21, v21
    v_mul_f32 v18, v18, v20
    v_mul_f32 v19, v19, v21
    v_cvt_pk_bf16_f32 v18, v18, v19
    ds_write_b32 v7, v18 offset:2304
    v_lshlrev_b32 v14, 16, v16
    v_and_b32 v15, 0xffff0000, v16
    s_load_dwordx8 s[52:59], s[0:1], 48
    s_load_dwordx2 s[46:47], s[0:1], 96
    v_bfe_u32 v11, v1, 1, 1
    v_lshlrev_b32 v10, 14, v11
    v_sub_u32 v10, v3, v10
    v_mul_u32_u24 v11, 320, v11
    v_sub_u32 v11, v4, v11
    s_and_b32 s6, s3, 1
    s_mul_i32 s6, s6, 576
    v_add_u32 v11, s6, v11
    s_waitcnt lgkmcnt(0)
    s_barrier
    ds_read_b64_tr_b16 v[40:41], v10 offset:0
    ds_read_b64_tr_b16 v[42:43], v10 offset:512
    ds_read_b64_tr_b16 v[44:45], v10 offset:4096
    ds_read_b64_tr_b16 v[46:47], v10 offset:4608
    ds_read_b64_tr_b16 v[48:49], v10 offset:8192
    ds_read_b64_tr_b16 v[50:51], v10 offset:8704
    ds_read_b64_tr_b16 v[52:53], v10 offset:12288
    ds_read_b64_tr_b16 v[54:55], v10 offset:12800
    ds_read_b128 v[136:139], v11 offset:2304
    ds_read_b128 v[140:143], v11 offset:2368
    ds_read_b128 v[144:147], v11 offset:2432
    ds_read_b128 v[148:151], v11 offset:2496
    s_waitcnt lgkmcnt(3)
    v_mfma_f32_16x16x32_bf16 v[32:35], v[136:139], v[40:43], 0
    s_waitcnt lgkmcnt(2)
    v_mfma_f32_16x16x32_bf16 v[32:35], v[140:143], v[44:47], v[32:35]
    s_waitcnt lgkmcnt(1)
    v_mfma_f32_16x16x32_bf16 v[32:35], v[144:147], v[48:51], v[32:35]
    s_waitcnt lgkmcnt(0)
    v_mfma_f32_16x16x32_bf16 v[32:35], v[148:151], v[52:55], v[32:35]
    s_nop 7
    v_add_f32_dpp v36, v34, v32 row_ror:8 row_mask:0xf bank_mask:0x3
    v_add_f32_dpp v36, v33, v35 row_ror:8 row_mask:0xf bank_mask:0xc
    s_and_b32 s6, s3, 1
    s_lshl_b32 s6, s6, 14
    s_lshr_b32 s7, s3, 1
    s_lshl_b32 s7, s7, 10
    s_add_u32 s6, s6, s7
    s_mov_b64 exec, 0xffff
    buffer_store_dwordx2 v[36:37], v8, s[16:19], s6 offen sc1
    s_mov_b64 exec, -1
    s_mov_b32 s20, s50
    s_mov_b32 s21, s51
    s_mov_b32 s22, 4194304
    s_mov_b32 s23, 0x20000
    s_lshl_b32 s27, s4, 11
    s_add_u32 s27, s27, s24
    s_add_u32 s27, s27, 180224
    s_lshl_b32 s28, s4, 10
    s_add_u32 s28, s28, 90112
    s_mov_b32 m0, s28
    s_add_u32 s28, s28, 8192
    buffer_load_dwordx4 v2, s[20:23], s27 offen nt lds
    s_add_u32 s27, s27, 16384
    s_mov_b32 m0, s28
    s_add_u32 s28, s28, 8192
    buffer_load_dwordx4 v2, s[20:23], s27 offen nt lds
    s_add_u32 s27, s27, 16384
    s_mov_b32 m0, s28
    s_add_u32 s28, s28, 8192
    buffer_load_dwordx4 v2, s[20:23], s27 offen nt lds
    s_add_u32 s27, s27, 16384
    s_mov_b32 m0, s28
    s_add_u32 s28, s28, 8192
    buffer_load_dwordx4 v2, s[20:23], s27 offen nt lds
    s_add_u32 s27, s27, 16384
    s_mov_b32 m0, s28
    s_nop 0
    buffer_load_dwordx4 v2, s[20:23], s27 offen nt lds
    s_barrier
    s_mov_b32 s20, s50
    s_mov_b32 s21, s51
    s_mov_b32 s22, 4194304
    s_mov_b32 s23, 0x20000
    s_lshl_b32 s27, s4, 11
    s_add_u32 s27, s27, s24
    s_add_u32 s27, s27, 0
    s_lshl_b32 s28, s4, 10
    s_add_u32 s28, s28, 0
    s_mov_b32 m0, s28
    s_add_u32 s28, s28, 8192
    buffer_load_dwordx4 v2, s[20:23], s27 offen nt lds
    s_add_u32 s27, s27, 16384
    s_mov_b32 m0, s28
    s_add_u32 s28, s28, 8192
    buffer_load_dwordx4 v2, s[20:23], s27 offen nt lds
    s_add_u32 s27, s27, 16384
    s_mov_b32 m0, s28
    s_add_u32 s28, s28, 8192
    buffer_load_dwordx4 v2, s[20:23], s27 offen nt lds
    s_add_u32 s27, s27, 16384
    s_mov_b32 m0, s28
    s_add_u32 s28, s28, 8192
    buffer_load_dwordx4 v2, s[20:23], s27 offen nt lds
    s_add_u32 s27, s27, 16384
    s_mov_b32 m0, s28
    s_add_u32 s28, s28, 8192
    buffer_load_dwordx4 v2, s[20:23], s27 offen nt lds
    s_add_u32 s27, s27, 16384
    s_mov_b32 m0, s28
    s_add_u32 s28, s28, 8192
    buffer_load_dwordx4 v2, s[20:23], s27 offen nt lds
    s_add_u32 s27, s27, 16384
    s_mov_b32 m0, s28
    s_add_u32 s28, s28, 8192
    buffer_load_dwordx4 v2, s[20:23], s27 offen nt lds
    s_add_u32 s27, s27, 16384
    s_mov_b32 m0, s28
    s_nop 0
    buffer_load_dwordx4 v2, s[20:23], s27 offen nt lds
    v_lshrrev_b32 v10, 4, v1
    v_bfe_u32 v11, v1, 2, 2
    v_lshl_add_u32 v10, v10, 3, v11
    v_lshlrev_b32 v10, 9, v10
    v_and_b32 v11, 3, v1
    v_lshl_add_u32 v10, v11, 3, v10
    v_bfe_u32 v11, v1, 2, 3
    v_lshlrev_b32 v11, 5, v11
    s_lshl_b32 s6, s4, 6
    v_xor_b32 v11, s6, v11
    v_add_u32 v22, v10, v11
    v_xor_b32 v11, 32, v11
    v_add_u32 v30, v10, v11
    s_getreg_b32 s6, hwreg(HW_REG_XCC_ID)
    s_and_b32 s31, s6, 15
    v_mov_b32 v38, s31
    s_lshl_b32 s6, s3, 7
    s_add_u32 s6, s6, 98304
    v_lshlrev_b32 v10, 3, v1
    s_cmp_eq_u32 s4, 0
    s_cselect_b32 exec_lo, 0xffff, 0
    s_mov_b32 exec_hi, 0
    s_cbranch_execz L_nxid
    buffer_store_dwordx2 v[38:39], v10, s[16:19], s6 offen sc1
L_nxid:
    s_mov_b64 exec, -1
    s_waitcnt vmcnt(8)
    s_barrier
    v_add_u32 v10, 65536, v22
    ds_read_b64_tr_b16 v[56:57], v10 offset:0
    ds_read_b64_tr_b16 v[58:59], v10 offset:2048
    ds_read_b64_tr_b16 v[60:61], v10 offset:16384
    ds_read_b64_tr_b16 v[62:63], v10 offset:18432
    ds_read_b64_tr_b16 v[64:65], v10 offset:32768
    ds_read_b64_tr_b16 v[66:67], v10 offset:34816
    ds_read_b64_tr_b16 v[68:69], v10 offset:49152
    ds_read_b64_tr_b16 v[70:71], v10 offset:51200
    v_add_u32 v11, 65536, v30
    ds_read_b64_tr_b16 v[88:89], v11 offset:0
    ds_read_b64_tr_b16 v[90:91], v11 offset:2048
    ds_read_b64_tr_b16 v[92:93], v11 offset:16384
    ds_read_b64_tr_b16 v[94:95], v11 offset:18432
    ds_read_b64_tr_b16 v[96:97], v11 offset:32768
    ds_read_b64_tr_b16 v[98:99], v11 offset:34816
    ds_read_b64_tr_b16 v[100:101], v11 offset:49152
    ds_read_b64_tr_b16 v[102:103], v11 offset:51200
    s_waitcnt lgkmcnt(0)
    s_barrier
    s_cmp_ge_u32 s3, 28
    s_cbranch_scc1 L_nom1
    s_lshl_b32 s24, s3, 7
    v_bfe_u32 v10, v1, 4, 1
    v_and_b32 v12, 7, v1
    v_xor_b32 v10, v10, v12
    s_and_b32 s27, s4, 4
    v_xor_b32 v10, s27, v10
    v_lshrrev_b32 v2, 3, v1
    v_mul_u32_u24 v2, 3584, v2
    v_xor_b32 v12, 2, v10
    v_lshl_add_u32 v12, v12, 4, v2
    v_lshl_add_u32 v2, v10, 4, v2
    s_mov_b32 s20, s52
    s_mov_b32 s21, s53
    s_mov_b32 s22, 1835008
    s_mov_b32 s23, 0x20000
    s_mul_i32 s27, s4, 229376
    s_add_u32 s27, s27, s24
    s_lshl_b32 s28, s4, 13
    s_add_u32 s28, s28, 65536
    s_mov_b32 m0, s28
    s_add_u32 s28, s28, 1024
    buffer_load_dwordx4 v2, s[20:23], s27 offen nt lds
    s_add_u32 s27, s27, 28672
    s_mov_b32 m0, s28
    s_add_u32 s28, s28, 1024
    buffer_load_dwordx4 v12, s[20:23], s27 offen nt lds
    s_add_u32 s27, s27, 28672
    s_mov_b32 m0, s28
    s_add_u32 s28, s28, 1024
    buffer_load_dwordx4 v2, s[20:23], s27 offen nt lds
    s_add_u32 s27, s27, 28672
    s_mov_b32 m0, s28
    s_add_u32 s28, s28, 1024
    buffer_load_dwordx4 v12, s[20:23], s27 offen nt lds
    s_add_u32 s27, s27, 28672
    s_mov_b32 m0, s28
    s_add_u32 s28, s28, 1024
    buffer_load_dwordx4 v2, s[20:23], s27 offen nt lds
    s_add_u32 s27, s27, 28672
    s_mov_b32 m0, s28
    s_add_u32 s28, s28, 1024
    buffer_load_dwordx4 v12, s[20:23], s27 offen nt lds
    s_add_u32 s27, s27, 28672
    s_mov_b32 m0, s28
    s_add_u32 s28, s28, 1024
    buffer_load_dwordx4 v2, s[20:23], s27 offen nt lds
    s_add_u32 s27, s27, 28672
    s_mov_b32 m0, s28
    s_nop 0
    buffer_load_dwordx4 v12, s[20:23], s27 offen nt lds
    s_waitcnt vmcnt(8)
    s_branch L_m1d
L_nom1:
    s_waitcnt vmcnt(0)
L_m1d:
    s_barrier
    ds_read_b64_tr_b16 v[40:41], v22 offset:0
    ds_read_b64_tr_b16 v[42:43], v22 offset:2048
    ds_read_b64_tr_b16 v[44:45], v22 offset:16384
    ds_read_b64_tr_b16 v[46:47], v22 offset:18432
    ds_read_b64_tr_b16 v[48:49], v22 offset:32768
    ds_read_b64_tr_b16 v[50:51], v22 offset:34816
    ds_read_b64_tr_b16 v[52:53], v22 offset:49152
    ds_read_b64_tr_b16 v[54:55], v22 offset:51200
    ds_read_b64_tr_b16 v[72:73], v30 offset:0
    ds_read_b64_tr_b16 v[74:75], v30 offset:2048
    ds_read_b64_tr_b16 v[76:77], v30 offset:16384
    ds_read_b64_tr_b16 v[78:79], v30 offset:18432
    ds_read_b64_tr_b16 v[80:81], v30 offset:32768
    ds_read_b64_tr_b16 v[82:83], v30 offset:34816
    ds_read_b64_tr_b16 v[84:85], v30 offset:49152
    ds_read_b64_tr_b16 v[86:87], v30 offset:51200
    s_waitcnt lgkmcnt(0)
    s_barrier
    s_cmp_ge_u32 s3, 28
    s_cbranch_scc1 L_nom2
    s_mov_b32 s20, s56
    s_mov_b32 s21, s57
    s_mov_b32 s22, 1835008
    s_mov_b32 s23, 0x20000
    s_and_b32 s6, s4, 1
    s_lshl_b32 s6, s6, 7
    v_lshlrev_b32 v2, 4, v1
    v_xor_b32 v2, s6, v2
    v_xor_b32 v10, 32, v2
    v_xor_b32 v11, 64, v2
    v_xor_b32 v12, 96, v2
    s_lshl_b32 s27, s3, 16
    s_lshl_b32 s28, s4, 13
    s_add_u32 s27, s27, s28
    s_mov_b32 m0, s28
    s_nop 0
    buffer_load_dwordx4 v2, s[20:23], s27 offen offset:0 nt lds
    buffer_load_dwordx4 v10, s[20:23], s27 offen offset:1024 nt lds
    buffer_load_dwordx4 v11, s[20:23], s27 offen offset:2048 nt lds
    buffer_load_dwordx4 v12, s[20:23], s27 offen offset:3072 nt lds
    s_add_u32 s27, s27, 4096
    s_add_u32 s28, s28, 4096
    s_mov_b32 m0, s28
    s_nop 0
    buffer_load_dwordx4 v2, s[20:23], s27 offen offset:0 nt lds
    buffer_load_dwordx4 v10, s[20:23], s27 offen offset:1024 nt lds
    buffer_load_dwordx4 v11, s[20:23], s27 offen offset:2048 nt lds
    buffer_load_dwordx4 v12, s[20:23], s27 offen offset:3072 nt lds
    s_lshl_b32 s6, s3, 11
    s_add_u32 s6, s6, 147456
    v_lshlrev_b32 v10, 2, v0
    buffer_load_dword v32, v10, s[16:19], s6 offen sc1
    v_and_b32 v10, 7, v1
    v_lshlrev_b32 v10, 1, v10
    s_and_b32 s6, s3, 15
    s_lshl_b32 s6, s6, 5
    s_lshl_b32 s7, s4, 2
    s_add_u32 s6, s6, s7
    v_and_b32 v11, 1, v1
    v_lshl_add_u32 v11, v11, 1, s6
    v_bfe_u32 v12, v1, 4, 1
    v_add_u32 v23, v11, v12
    v_lshlrev_b32 v11, 1, v23
    global_load_ushort v24, v11, s[58:59]
    s_lshl_b32 s6, s3, 7
    s_lshl_b32 s7, s4, 4
    s_add_u32 s6, s6, s7
    v_add_u32 v11, s6, v10
    global_load_ushort v25, v11, s[54:55]
L_nom2:
    s_lshl_b32 s6, s3, 10
    s_add_u32 s6, s6, 114688
    v_lshlrev_b32 v10, 4, v1
    buffer_load_dword v34, v10, s[16:19], s6 offen sc1
    v_and_b32 v10, 31, v1
    v_lshlrev_b32 v10, 7, v10
    s_mov_b32 s6, 98304
    s_mov_b32 s30, 0
L_vp_11:
    buffer_load_dwordx2 v[136:137], v10, s[16:19], s6 offen sc1
    s_add_u32 s30, s30, 1
    s_waitcnt vmcnt(0)
    v_cmp_ne_u32 vcc, s33, v137
    s_cbranch_vccz L_vd_12
    s_sleep 2
    s_cmp_lt_u32 s30, 1000000
    s_cbranch_scc1 L_vp_11
L_vd_12:
    v_cmp_ne_u32 vcc, s31, v136
    s_nop 0
    s_cmp_eq_u64 vcc, 0
    s_cselect_b32 s32, 1, 0
    s_cmp_ge_u32 s3, 28
    s_cbranch_scc1 L_wst
    s_barrier
    v_add_u32 v10, 65536, v3
    ds_read_b64_tr_b16 v[104:105], v10 offset:0
    ds_read_b64_tr_b16 v[106:107], v10 offset:512
    ds_read_b64_tr_b16 v[108:109], v10 offset:4096
    ds_read_b64_tr_b16 v[110:111], v10 offset:4608
    ds_read_b64_tr_b16 v[112:113], v10 offset:8192
    ds_read_b64_tr_b16 v[114:115], v10 offset:8704
    ds_read_b64_tr_b16 v[116:117], v10 offset:12288
    ds_read_b64_tr_b16 v[118:119], v10 offset:12800
    ds_read_b64_tr_b16 v[120:121], v10 offset:16384
    ds_read_b64_tr_b16 v[122:123], v10 offset:16896
    ds_read_b64_tr_b16 v[124:125], v10 offset:20480
    ds_read_b64_tr_b16 v[126:127], v10 offset:20992
    ds_read_b64_tr_b16 v[128:129], v10 offset:24576
    ds_read_b64_tr_b16 v[130:131], v10 offset:25088
    ds_read_b64_tr_b16 v[132:133], v10 offset:28672
    ds_read_b64_tr_b16 v[134:135], v10 offset:29184
    v_lshrrev_b32 v11, 3, v23
    v_lshlrev_b32 v11, 7, v11
    v_and_b32 v12, 7, v23
    v_lshl_add_u32 v11, v12, 3, v11
    v_bfe_u32 v12, v1, 3, 1
    v_lshl_add_u32 v11, v12, 6, v11
    s_mov_b32 s63, 57344
    s_mov_b32 s60, 32768
    s_mov_b32 s61, 40960
    s_mov_b32 s62, 49152
    v_lshlrev_b32 v24, 16, v24
    v_lshlrev_b32 v25, 16, v25
    v_mov_b32 v151, 0x3f803f80
    ds_write_b32 v7, v151 offset:11616
    s_mov_b32 s30, 0
L_vp_14:
    buffer_load_dwordx4 v[136:139], v28, s[16:19], s60 offen sc1
    buffer_load_dwordx4 v[140:143], v28, s[16:19], s61 offen sc1
    buffer_load_dwordx4 v[144:147], v28, s[16:19], s62 offen sc1
    buffer_load_dwordx2 v[148:149], v11, s[16:19], s63 offen sc1
    s_add_u32 s30, s30, 1
    s_waitcnt vmcnt(0)
    v_max3_u32 v150, v137, v139, v141
    v_max3_u32 v150, v150, v143, v145
    v_max3_u32 v150, v150, v147, v149
    v_min3_u32 v151, v137, v139, v141
    v_min3_u32 v151, v151, v143, v145
    v_min3_u32 v151, v151, v147, v149
    v_cmp_ne_u32 vcc, s33, v150
    v_cmp_ne_u32 s[34:35], s33, v151
    s_nop 0
    s_or_b64 vcc, vcc, s[34:35]
    s_cbranch_vccz L_vd_15
    s_sleep 2
    s_cmp_lt_u32 s30, 1000000
    s_cbranch_scc1 L_vp_14
L_vd_15:
    v_mov_b32 v23, v148
    v_mov_b32 v16, v136
    v_mov_b32 v17, v138
    v_add_f32 v18, 1.0, v144
    v_add_f32 v19, 1.0, v146
    v_cvt_pk_bf16_f32 v137, v140, v142
    v_cvt_pk_bf16_f32 v139, v18, v19
    v_lshlrev_b32 v18, 16, v139
    v_and_b32 v19, 0xffff0000, v139
    v_lshlrev_b32 v20, 16, v137
    v_and_b32 v21, 0xffff0000, v137
    ds_write_b32 v7, v139 offset:6944
    ds_write_b32 v7, v137 offset:9280
    v_add_f32 v152, v18, v19
    v_mul_f32 v153, v18, v18
    v_fmac_f32 v153, v19, v19
    v_mul_f32 v154, v18, v20
    v_fmac_f32 v154, v19, v21
    v_add_f32 v155, v20, v21
    v_mul_f32 v156, v20, v20
    v_fmac_f32 v156, v21, v21
    v_add_f32_dpp v158, v152, v152 row_ror:8 row_mask:0xf bank_mask:0x3
    v_add_f32_dpp v159, v154, v154 row_ror:8 row_mask:0xf bank_mask:0x3
    v_add_f32_dpp v160, v156, v156 row_ror:8 row_mask:0xf bank_mask:0x3
    v_add_f32_dpp v158, v153, v153 row_ror:8 row_mask:0xf bank_mask:0xc
    v_add_f32_dpp v159, v155, v155 row_ror:8 row_mask:0xf bank_mask:0xc
    v_add_f32_dpp v160, v156, v156 row_ror:8 row_mask:0xf bank_mask:0xc
    s_nop 0
    v_permlane16_swap_b32 v158, v159
    v_permlane16_swap_b32 v160, v161
    v_add_f32 v158, v158, v159
    v_add_f32 v160, v160, v161
    s_nop 1
    v_permlane32_swap_b32 v158, v160
    v_add_f32 v158, v158, v160
    s_nop 1
    v_add_f32_dpp v158, v158, v158 quad_perm:[1,0,3,2] row_mask:0xf bank_mask:0xf
    s_nop 1
    v_add_f32_dpp v158, v158, v158 quad_perm:[2,3,0,1] row_mask:0xf bank_mask:0xf
    s_mov_b32 exec_lo, 0x11111111
    s_mov_b32 exec_hi, 0x1111
    ds_add_f32 v13, v158 offset:128
    s_mov_b64 exec, -1
    v_bfe_u32 v10, v1, 2, 2
    v_mul_u32_u24 v10, 2336, v10
    v_add_u32 v10, v10, v4
    s_waitcnt lgkmcnt(0)
    s_barrier
    ds_read_b128 v[136:139], v10 offset:4608
    ds_read_b128 v[140:143], v10 offset:4672
    ds_read_b128 v[144:147], v10 offset:4736
    ds_read_b128 v[148:151], v10 offset:4800
    ds_read_b128 v[152:155], v10 offset:4864
    ds_read_b128 v[156:159], v10 offset:4928
    ds_read_b128 v[160:163], v10 offset:4992
    ds_read_b128 v[164:167], v10 offset:5056
    s_waitcnt lgkmcnt(7)
    v_mfma_f32_16x16x32_bf16 v[32:35], v[136:139], v[104:107], 0
    s_waitcnt lgkmcnt(6)
    v_mfma_f32_16x16x32_bf16 v[32:35], v[140:143], v[108:111], v[32:35]
    s_waitcnt lgkmcnt(5)
    v_mfma_f32_16x16x32_bf16 v[32:35], v[144:147], v[112:115], v[32:35]
    s_waitcnt lgkmcnt(4)
    v_mfma_f32_16x16x32_bf16 v[32:35], v[148:151], v[116:119], v[32:35]
    s_waitcnt lgkmcnt(3)
    v_mfma_f32_16x16x32_bf16 v[32:35], v[152:155], v[120:123], v[32:35]
    s_waitcnt lgkmcnt(2)
    v_mfma_f32_16x16x32_bf16 v[32:35], v[156:159], v[124:127], v[32:35]
    s_waitcnt lgkmcnt(1)
    v_mfma_f32_16x16x32_bf16 v[32:35], v[160:163], v[128:131], v[32:35]
    s_waitcnt lgkmcnt(0)
    v_mfma_f32_16x16x32_bf16 v[32:35], v[164:167], v[132:135], v[32:35]
    s_nop 7
    v_add_f32_dpp v36, v34, v32 row_ror:8 row_mask:0xf bank_mask:0x3
    v_add_f32_dpp v36, v33, v35 row_ror:8 row_mask:0xf bank_mask:0xc
    v_mov_b32 v26, v36
    s_nop 1
    v_permlane16_swap_b32 v36, v26
    v_mov_b32 v27, v36
    v_mov_b32 v28, v26
    s_nop 0
    v_permlane32_swap_b32 v36, v27
    v_permlane32_swap_b32 v26, v28
L_wst:
    s_lshr_b32 s6, s4, 2
    s_lshl_b32 s24, s6, 3
    s_lshr_b32 s7, s26, 1
    s_add_u32 s24, s24, s7
    s_and_b32 s7, s26, 1
    s_lshl_b32 s7, s7, 1
    s_bfe_u32 s28, s4, 0x10001
    s_add_u32 s7, s7, s28
    s_lshl_b32 s27, s24, 11
    s_lshl_b32 s29, s7, 3
    s_add_u32 s27, s27, s29
    s_add_u32 s27, s27, 589824
    s_lshl_b32 s60, s24, 14
    s_lshl_b32 s29, s7, 8
    s_add_u32 s60, s60, s29
    s_and_b32 s29, s4, 1
    s_lshl_b32 s29, s29, 7
    s_add_u32 s60, s60, s29
    s_add_u32 s60, s60, 262144
    s_add_u32 s61, s60, 4096
    s_mul_i32 s6, s6, 1152
    s_and_b32 s29, s4, 3
    s_lshl_b32 s29, s29, 6
    s_add_u32 s6, s6, s29
    s_add_u32 s6, s6, 131072
    v_and_b32 v31, 1, v1
    v_mul_u32_u24 v31, 576, v31
    v_bfe_u32 v10, v1, 1, 4
    v_lshl_add_u32 v31, v10, 2, v31
    v_add_u32 v31, s6, v31
    s_mov_b32 s62, 6144
    v_and_b32 v2, 31, v1
    v_lshlrev_b32 v2, 2, v2
    v_lshrrev_b32 v10, 5, v1
    v_mad_u32_u24 v2, v10, s62, v2
    s_lshl_b32 s29, s3, 10
    s_add_u32 s29, s29, 114688
    v_and_b32 v11, 2, v1
    v_cmp_eq_u32 vcc, 0, v11
    v_mov_b32 v11, 0xeeee
    v_mov_b32 v22, 0x4444
    v_cndmask_b32 v22, v11, v22, vcc
    v_mov_b32 v32, 0
    v_mov_b32 v33, 0
    v_mov_b32 v34, 0
    v_mov_b32 v35, 0
    v_mov_b32 v36, 0
    v_mov_b32 v37, 0
    v_mov_b32 v38, 0
    v_mov_b32 v39, 0
    v_bfe_u32 v8, v1, 1, 2
    v_lshlrev_b32 v8, 4, v8
    v_bfe_u32 v11, v1, 4, 1
    v_lshl_add_u32 v8, v11, 6, v8
    v_bfe_u32 v11, v1, 3, 1
    v_lshl_add_u32 v8, v11, 7, v8
    v_lshl_add_u32 v8, v10, 2, v8
    s_lshr_b32 s6, s4, 1
    s_lshl_b32 s6, s6, 8
    s_and_b32 s7, s4, 1
    s_lshl_b32 s7, s7, 3
    s_add_u32 s6, s6, s7
    v_add_u32 v8, s6, v8
    v_lshlrev_b32 v10, 7, v1
    v_mov_b32 v136, 0xff800000
    s_mov_b64 exec, 0xfff
    s_mov_b32 s30, 0
L_vp_17:
    buffer_load_dwordx2 v[136:137], v10, s[16:19], s27 offen sc1
    s_add_u32 s30, s30, 1
    s_waitcnt vmcnt(0)
    v_cmp_ne_u32 vcc, s33, v137
    s_cbranch_vccz L_vd_18
    s_sleep 2
    s_cmp_lt_u32 s30, 1000000
    s_cbranch_scc1 L_vp_17
L_vd_18:
    s_mov_b64 exec, -1
    v_mov_b32 v137, v136
    s_nop 1
    v_max_f32_dpp v137, v137, v137 row_ror:1 row_mask:0xf bank_mask:0xf
    s_nop 1
    v_max_f32_dpp v137, v137, v137 row_ror:2 row_mask:0xf bank_mask:0xf
    s_nop 1
    v_max_f32_dpp v137, v137, v137 row_ror:4 row_mask:0xf bank_mask:0xf
    s_nop 1
    v_max_f32_dpp v137, v137, v137 row_ror:8 row_mask:0xf bank_mask:0xf
    v_sub_f32 v136, v136, v137
    v_exp_f32 v136, v136
    s_nop 0
    v_mov_b32 v137, v136
    s_nop 1
    v_add_f32_dpp v137, v137, v137 row_ror:1 row_mask:0xf bank_mask:0xf
    s_nop 1
    v_add_f32_dpp v137, v137, v137 row_ror:2 row_mask:0xf bank_mask:0xf
    s_nop 1
    v_add_f32_dpp v137, v137, v137 row_ror:4 row_mask:0xf bank_mask:0xf
    s_nop 1
    v_add_f32_dpp v137, v137, v137 row_ror:8 row_mask:0xf bank_mask:0xf
    v_rcp_f32 v137, v137
    s_nop 0
    v_mul_f32 v136, v136, v137
    v_lshrrev_b32 v10, 5, v1
    v_mul_u32_u24 v10, 24, v10
    ds_bpermute_b32 v160, v10, v136 offset:0
    ds_bpermute_b32 v161, v10, v136 offset:4
    ds_bpermute_b32 v162, v10, v136 offset:8
    ds_bpermute_b32 v163, v10, v136 offset:12
    ds_bpermute_b32 v164, v10, v136 offset:16
    ds_bpermute_b32 v165, v10, v136 offset:20
    s_waitcnt lgkmcnt(0)
    s_mov_b32 s30, 0
L_vp_20:
    buffer_load_dword v136, v2, s[16:19], s60 offen offset:0 sc1
    buffer_load_dword v137, v2, s[16:19], s60 offen offset:1024 sc1
    buffer_load_dword v138, v2, s[16:19], s60 offen offset:2048 sc1
    buffer_load_dword v139, v2, s[16:19], s60 offen offset:3072 sc1
    buffer_load_dword v140, v2, s[16:19], s61 offen offset:0 sc1
    buffer_load_dword v141, v2, s[16:19], s61 offen offset:1024 sc1
    s_add_u32 s30, s30, 1
    s_waitcnt vmcnt(0)
    v_max3_u32 v148, v136, v137, v138
    v_max3_u32 v148, v148, v139, v140
    v_max_u32 v148, v148, v141
    v_cmp_eq_u32 vcc, -1, v148
    s_cbranch_vccz L_vd_21
    s_cmp_lt_u32 s30, 1000000
    s_cbranch_scc1 L_vp_20
L_vd_21:
    v_lshlrev_b32 v144, 16, v136
    v_and_b32 v145, 0xffff0000, v136
    v_lshlrev_b32 v146, 16, v137
    v_and_b32 v147, 0xffff0000, v137
    v_lshlrev_b32 v148, 16, v138
    v_and_b32 v149, 0xffff0000, v138
    v_lshlrev_b32 v150, 16, v139
    v_and_b32 v151, 0xffff0000, v139
    v_lshlrev_b32 v152, 16, v140
    v_and_b32 v153, 0xffff0000, v140
    v_lshlrev_b32 v154, 16, v141
    v_and_b32 v155, 0xffff0000, v141
    v_pk_mul_f32 v[156:157], v[144:145], v[160:161] op_sel_hi:[1,0]
    v_pk_mul_f32 v[158:159], v[146:147], v[160:161] op_sel:[0,1] op_sel_hi:[1,1]
    v_pk_fma_f32 v[156:157], v[148:149], v[162:163], v[156:157] op_sel_hi:[1,0,1]
    v_pk_fma_f32 v[158:159], v[150:151], v[162:163], v[158:159] op_sel:[0,1,0] op_sel_hi:[1,1,1]
    v_pk_fma_f32 v[156:157], v[152:153], v[164:165], v[156:157] op_sel_hi:[1,0,1]
    v_pk_fma_f32 v[158:159], v[154:155], v[164:165], v[158:159] op_sel:[0,1,0] op_sel_hi:[1,1,1]
    s_nop 0
    v_pk_add_f32 v[156:157], v[156:157], v[158:159]
    s_nop 1
    v_permlane32_swap_b32 v156, v157
    v_add_f32 v156, v156, v157
    v_mov_b32 v157, v156
    s_nop 1
    v_permlane32_swap_b32 v156, v157
    s_mov_b64 exec, 0xffffffff
    v_cvt_pk_bf16_f32 v156, v156, v157
    ds_write_b32 v31, v156
    s_mov_b64 exec, -1
    s_waitcnt lgkmcnt(0)
    s_barrier
    ds_read_b128 v[136:139], v4 offset:0
    ds_read_b128 v[140:143], v4 offset:64
    ds_read_b128 v[144:147], v4 offset:128
    ds_read_b128 v[148:151], v4 offset:192
    s_waitcnt lgkmcnt(3)
    v_smfmac_f32_16x16x64_bf16 v[32:35], v[136:139], v[40:47], v22
    v_smfmac_f32_16x16x64_bf16 v[36:39], v[136:139], v[72:79], v22
    s_waitcnt lgkmcnt(2)
    v_smfmac_f32_16x16x64_bf16 v[32:35], v[140:143], v[48:55], v22
    v_smfmac_f32_16x16x64_bf16 v[36:39], v[140:143], v[80:87], v22
    s_waitcnt lgkmcnt(1)
    v_smfmac_f32_16x16x64_bf16 v[32:35], v[144:147], v[56:63], v22
    v_smfmac_f32_16x16x64_bf16 v[36:39], v[144:147], v[88:95], v22
    s_waitcnt lgkmcnt(0)
    v_smfmac_f32_16x16x64_bf16 v[32:35], v[148:151], v[64:71], v22
    v_smfmac_f32_16x16x64_bf16 v[36:39], v[148:151], v[96:103], v22
    s_nop 6
    v_add_f32_dpp v10, v32, v34 quad_perm:[0,1,2,3] row_mask:0x1 bank_mask:0xf
    v_add_f32_dpp v10, v33, v35 quad_perm:[0,1,2,3] row_mask:0x2 bank_mask:0xf
    v_add_f32_dpp v10, v36, v38 quad_perm:[0,1,2,3] row_mask:0x4 bank_mask:0xf
    v_add_f32_dpp v10, v37, v39 quad_perm:[0,1,2,3] row_mask:0x8 bank_mask:0xf
    s_cmp_lg_u32 s32, 0
    s_nop 0
    v_mov_b32_dpp v11, v10 quad_perm:[1,1,3,3] row_mask:0xf bank_mask:0xf
    s_mov_b32 exec_lo, 0x55555555
    s_mov_b32 exec_hi, 0x55555555
    v_cvt_pk_bf16_f32 v11, v10, v11
    s_cbranch_scc1 L_fs_23
    buffer_store_dword v11, v8, s[16:19], s29 offen sc1
    s_branch L_fd_24
L_fs_23:
    buffer_store_dword v11, v8, s[16:19], s29 offen
L_fd_24:
    s_mov_b64 exec, -1
    s_cmp_ge_u32 s3, 28
    s_cbranch_scc1 L_hdone
    v_lshrrev_b32 v10, 4, v1
    v_bfe_u32 v11, v1, 2, 2
    v_lshl_add_u32 v10, v10, 3, v11
    v_lshlrev_b32 v10, 10, v10
    v_and_b32 v11, 3, v1
    v_lshl_add_u32 v10, v11, 3, v10
    v_bfe_u32 v11, v1, 2, 3
    v_lshlrev_b32 v11, 5, v11
    s_lshl_b32 s6, s4, 7
    v_xor_b32 v11, s6, v11
    v_xor_b32 v12, 0, v11
    v_add_u32 v60, v10, v12
    v_xor_b32 v12, 32, v11
    v_add_u32 v61, v10, v12
    v_xor_b32 v12, 64, v11
    v_add_u32 v62, v10, v12
    v_xor_b32 v12, 96, v11
    v_add_u32 v63, v10, v12
    ds_read_b64_tr_b16 v[72:73], v60 offset:0
    ds_read_b64_tr_b16 v[74:75], v60 offset:4096
    ds_read_b64_tr_b16 v[76:77], v60 offset:32768
    ds_read_b64_tr_b16 v[78:79], v60 offset:36864
    ds_read_b64_tr_b16 v[80:81], v61 offset:0
    ds_read_b64_tr_b16 v[82:83], v61 offset:4096
    ds_read_b64_tr_b16 v[84:85], v61 offset:32768
    ds_read_b64_tr_b16 v[86:87], v61 offset:36864
    ds_read_b64_tr_b16 v[88:89], v62 offset:0
    ds_read_b64_tr_b16 v[90:91], v62 offset:4096
    ds_read_b64_tr_b16 v[92:93], v62 offset:32768
    ds_read_b64_tr_b16 v[94:95], v62 offset:36864
    ds_read_b64_tr_b16 v[96:97], v63 offset:0
    ds_read_b64_tr_b16 v[98:99], v63 offset:4096
    ds_read_b64_tr_b16 v[100:101], v63 offset:32768
    ds_read_b64_tr_b16 v[102:103], v63 offset:36864
    s_lshl_b32 s60, s4, 8
    s_add_u32 s60, s60, 114688
    s_add_u32 s61, s60, 4096
    v_and_b32 v59, 15, v1
    v_lshlrev_b32 v59, 4, v59
    v_lshrrev_b32 v58, 4, v1
    v_lshl_add_u32 v59, v58, 13, v59
    buffer_load_dwordx4 v[136:139], v59, s[16:19], s60 offen offset:0 sc1
    buffer_load_dwordx4 v[140:143], v59, s[16:19], s60 offen offset:2048 sc1
    buffer_load_dwordx4 v[144:147], v59, s[16:19], s61 offen offset:0 sc1
    buffer_load_dwordx4 v[148:151], v59, s[16:19], s61 offen offset:2048 sc1
    v_bfe_u32 v10, v1, 3, 1
    v_lshlrev_b32 v40, 5, v10
    v_add_u32 v40, 145408, v40
    ds_read_b128 v[68:71], v40 offset:128
    ds_read_b32 v30, v40 offset:144
    v_bfe_u32 v11, v1, 1, 1
    v_lshl_add_u32 v41, v10, 1, v11
    v_lshlrev_b32 v41, 6, v41
    v_and_b32 v12, 4, v1
    v_add_u32 v41, v41, v12
    v_and_b32 v12, 1, v1
    v_lshl_add_u32 v41, v12, 1, v41
    s_lshl_b32 s6, s4, 3
    s_add_u32 s6, s6, 145024
    v_add_u32 v41, s6, v41
    v_lshl_add_u32 v42, v12, 1, v11
    v_lshlrev_b32 v42, 6, v42
    v_and_b32 v45, 48, v1
    v_add_u32 v42, v42, v45
    v_add_u32 v42, 145024, v42
    v_and_b32 v43, 7, v1
    v_mul_u32_u24 v43, 288, v43
    v_add_u32 v43, v43, v45
    v_add_u32 v43, 149760, v43
    v_bfe_u32 v46, v1, 2, 1
    v_lshl_add_u32 v46, v12, 2, v46
    v_mul_u32_u24 v46, 288, v46
    v_lshl_add_u32 v46, v11, 2, v46
    v_lshrrev_b32 v11, 3, v1
    v_lshl_add_u32 v46, v11, 3, v46
    s_lshr_b32 s6, s4, 2
    s_mul_i32 s6, s6, 576
    s_and_b32 s7, s4, 3
    s_lshl_b32 s7, s7, 6
    s_add_u32 s6, s6, s7
    s_add_u32 s6, s6, 149760
    v_add_u32 v46, s6, v46
    v_and_b32 v11, 4, v1
    v_cmp_eq_u32 vcc, 0, v11
    v_mov_b32 v11, 0xeeee
    v_mov_b32 v47, 0x4444
    v_cndmask_b32 v47, v11, v47, vcc
    v_mov_b32 v32, 0
    v_mov_b32 v33, 0
    v_mov_b32 v34, 0
    v_mov_b32 v35, 0
    s_and_b32 s6, s3, 15
    s_lshl_b32 s6, s6, 5
    s_lshl_b32 s7, s4, 2
    s_add_u32 s6, s6, s7
    v_and_b32 v11, 1, v1
    v_lshl_add_u32 v11, v11, 1, s6
    v_lshrrev_b32 v12, 1, v1
    v_lshlrev_b32 v44, 11, v12
    v_lshl_add_u32 v44, v11, 2, v44
    v_lshlrev_b32 v45, 2, v0
    v_bfe_u32 v12, v1, 4, 1
    v_add_u32 v11, v11, v12
    v_lshlrev_b32 v48, 11, v10
    v_lshl_add_u32 v48, v11, 2, v48
    v_add_u32 v48, 145664, v48
    v_lshlrev_b32 v49, 10, v10
    v_lshl_add_u32 v49, v11, 1, v49
    s_add_u32 s20, s14, 147456
    s_addc_u32 s21, s15, 0
    s_mov_b32 s22, 57344
    s_mov_b32 s23, 0x20000
    s_lshl_b32 s24, s3, 11
    s_mov_b32 s40, 0x3b000000
    s_mov_b32 s41, 0x3727c5ac
    s_mov_b32 s42, 0x3d372713
    s_mov_b32 s43, 0xc0135761
    v_and_b32 v50, 1, v1
    v_lshlrev_b32 v50, 4, v50
    v_mov_b32 v51, 0x3f80
    v_lshlrev_b32 v50, v50, v51
    v_bfe_u32 v51, v1, 2, 2
    v_cmp_eq_u32 vcc, 0, v51
    s_nop 1
    v_cndmask_b32 v64, 0, v50, vcc
    v_cmp_eq_u32 vcc, 1, v51
    s_nop 1
    v_cndmask_b32 v65, 0, v50, vcc
    v_cmp_eq_u32 vcc, 2, v51
    s_nop 1
    v_cndmask_b32 v66, 0, v50, vcc
    v_cmp_eq_u32 vcc, 3, v51
    s_nop 1
    v_cndmask_b32 v67, 0, v50, vcc
    s_waitcnt lgkmcnt(0)
    s_mov_b32 s45, 0x3b800000
    v_mov_b32 v50, s41
    v_mul_f32 v68, s40, v68
    v_mul_f32 v69, s40, v69
    v_mul_f32 v70, s45, v70
    v_mul_f32 v71, s40, v71
    v_fma_f32 v30, v30, s40, v50
    v_lshrrev_b32 v50, 3, v1
    v_mov_b32 v51, s40
    v_cmp_eq_u32 vcc, 5, v50
    v_mov_b32 v58, s45
    s_nop 0
    v_cndmask_b32 v51, v51, v58, vcc
    v_cmp_eq_u32 vcc, 4, v50
    s_nop 1
    v_cndmask_b32 v51, v51, -v58, vcc
    v_mov_b32 v29, v9
    v_mov_b32 v31, v13
    v_mov_b32 v0, 0
    v_mov_b32 v1, 0
    v_mov_b32 v2, 0
    v_mov_b32 v3, 0
    v_mov_b32 v60, 0
    v_mov_b32 v61, 0
    v_mov_b32 v62, 0
    v_mov_b32 v63, 0
    v_mov_b32 v6, 0
    v_mov_b32 v7, 0
    v_mov_b32 v8, 0
    v_mov_b32 v9, 0
    v_mov_b32 v10, 0
    v_mov_b32 v11, 0
    v_mov_b32 v12, 0
    v_mov_b32 v13, 0
    s_mov_b32 s30, 0
L_mp_25:
    s_waitcnt vmcnt(0)
    v_max3_u32 v156, v136, v137, v138
    v_max_u32 v156, v156, v139
    v_max3_u32 v157, v140, v141, v142
    v_max_u32 v157, v157, v143
    v_max3_u32 v158, v144, v145, v146
    v_max_u32 v158, v158, v147
    v_max3_u32 v159, v148, v149, v150
    v_max_u32 v159, v159, v151
    v_cmp_eq_u32 s[48:49], -1, v156
    v_cmp_eq_u32 s[50:51], -1, v157
    v_cmp_eq_u32 s[52:53], -1, v158
    v_cmp_eq_u32 s[54:55], -1, v159
    s_or_b64 s[34:35], s[48:49], s[50:51]
    s_or_b64 s[34:35], s[34:35], s[52:53]
    s_or_b64 s[34:35], s[34:35], s[54:55]
    s_cbranch_scc0 L_md_26
    s_mov_b64 exec, s[48:49]
    buffer_load_dwordx4 v[136:139], v59, s[16:19], s60 offen offset:0 sc1
    s_mov_b64 exec, s[50:51]
    buffer_load_dwordx4 v[140:143], v59, s[16:19], s60 offen offset:2048 sc1
    s_mov_b64 exec, s[52:53]
    buffer_load_dwordx4 v[144:147], v59, s[16:19], s61 offen offset:0 sc1
    s_mov_b64 exec, s[54:55]
    buffer_load_dwordx4 v[148:151], v59, s[16:19], s61 offen offset:2048 sc1
    s_mov_b64 exec, -1
    s_add_u32 s30, s30, 1
    s_cmp_lt_u32 s30, 1000000
    s_cbranch_scc1 L_mp_25
    s_waitcnt vmcnt(0)
L_md_26:
    v_mfma_f32_16x16x32_bf16 v[152:155], v[64:67], v[136:139], 0
    v_mfma_f32_16x16x32_bf16 v[152:155], v[64:67], v[140:143], v[152:155]
    v_mfma_f32_16x16x32_bf16 v[152:155], v[64:67], v[144:147], v[152:155]
    v_mfma_f32_16x16x32_bf16 v[152:155], v[64:67], v[148:151], v[152:155]
    s_nop 7
    v_fma_f32 v148, v16, v152, v14
    v_fma_f32 v149, v17, v153, v15
    v_mul_f32 v150, v148, v18
    v_mul_f32 v151, v149, v19
    v_cvt_pk_bf16_f32 v136, v150, v151
    ds_write_b32 v46, v136
    ds_write_b64 v29, v[148:149]
    v_add_f32 v156, v148, v149
    v_mul_f32 v157, v148, v148
    v_add_f32 v158, v150, v151
    v_mul_f32 v159, v150, v150
    v_mul_f32 v160, v150, v18
    v_mul_f32 v161, v150, v20
    v_fmac_f32 v157, v149, v149
    v_fmac_f32 v159, v151, v151
    v_fmac_f32 v160, v151, v19
    v_fmac_f32 v161, v151, v21
    v_add_f32_dpp v162, v156, v156 row_ror:8 row_mask:0xf bank_mask:0x3
    v_add_f32_dpp v163, v158, v158 row_ror:8 row_mask:0xf bank_mask:0x3
    v_add_f32_dpp v164, v160, v160 row_ror:8 row_mask:0xf bank_mask:0x3
    v_add_f32_dpp v162, v157, v157 row_ror:8 row_mask:0xf bank_mask:0xc
    v_add_f32_dpp v163, v159, v159 row_ror:8 row_mask:0xf bank_mask:0xc
    v_add_f32_dpp v164, v161, v161 row_ror:8 row_mask:0xf bank_mask:0xc
    s_nop 0
    v_permlane16_swap_b32 v162, v163
    v_permlane16_swap_b32 v164, v165
    v_add_f32 v162, v162, v163
    v_add_f32 v164, v164, v165
    s_nop 1
    v_permlane32_swap_b32 v162, v164
    v_add_f32 v162, v162, v164
    s_nop 1
    v_add_f32_dpp v162, v162, v162 quad_perm:[1,0,3,2] row_mask:0xf bank_mask:0xf
    s_nop 1
    v_add_f32_dpp v162, v162, v162 quad_perm:[2,3,0,1] row_mask:0xf bank_mask:0xf
    s_mov_b32 exec_lo, 0x11111111
    s_mov_b32 exec_hi, 0x1111
    v_mul_f32 v162, v162, v51
    ds_add_f32 v31, v162 offset:0
    s_mov_b64 exec, -1
    s_waitcnt lgkmcnt(0)
    s_barrier
    ds_read_b128 v[136:139], v43 offset:0
    ds_read_b128 v[140:143], v43 offset:64
    ds_read_b128 v[52:55], v40
    ds_read_b64 v[56:57], v40 offset:16
    ds_read_b128 v[144:147], v43 offset:128
    ds_read_b128 v[148:151], v43 offset:192
    s_waitcnt lgkmcnt(5)
    v_smfmac_f32_16x16x64_bf16 v[32:35], v[136:139], v[104:111], v47
    s_waitcnt lgkmcnt(4)
    v_smfmac_f32_16x16x64_bf16 v[32:35], v[140:143], v[112:119], v47
    s_waitcnt lgkmcnt(2)
    v_fma_f32 v53, -v52, v52, v53
    v_fma_f32 v56, v52, v69, v56
    v_max_f32 v53, s41, v53
    v_fma_f32 v54, -v52, v68, v54
    s_waitcnt lgkmcnt(1)
    v_smfmac_f32_16x16x64_bf16 v[32:35], v[144:147], v[120:127], v47
    v_rsq_f32 v53, v53
    v_fma_f32 v55, v52, v56, v55
    s_waitcnt lgkmcnt(0)
    v_smfmac_f32_16x16x64_bf16 v[32:35], v[148:151], v[128:135], v47
    v_fma_f32 v57, -v52, v70, v57
    v_fma_f32 v55, v53, v55, v57
    v_fma_f32 v54, v53, v54, v71
    v_mul_f32 v52, v52, v53
    v_fma_f32 v55, v53, v55, v30
    v_fma_f32 v56, -v52, v26, v27
    v_fma_f32 v55, -v54, v54, v55
    v_fma_f32 v56, -v54, v28, v56
    v_max_f32 v55, s41, v55
    v_rsq_f32 v55, v55
    v_add_f32_dpp v36, v34, v32 row_ror:8 row_mask:0xf bank_mask:0x3
    v_add_f32_dpp v36, v33, v35 row_ror:8 row_mask:0xf bank_mask:0xc
    v_mov_b32 v38, v36
    s_nop 1
    v_permlane16_swap_b32 v36, v38
    v_add_f32 v36, v36, v38
    v_fma_f32 v36, v36, v53, v56
    v_fma_f32 v36, v36, v55, v25
    v_mul_f32 v38, v36, v36
    v_mul_f32 v39, s43, v36
    v_fma_f32 v38, v38, s42, 1.0
    v_mul_f32 v38, v38, v39
    v_exp_f32 v38, v38
    s_nop 0
    v_add_f32 v38, 1.0, v38
    v_rcp_f32 v38, v38
    s_nop 0
    v_mul_f32 v38, v38, v36
    v_cvt_pk_bf16_f32 v38, v38, v38
    s_mov_b64 exec, 0xffff
    ds_write_b16 v41, v38
    s_mov_b64 exec, -1
    s_waitcnt lgkmcnt(0)
    s_barrier
    ds_read_b128 v[136:139], v42
    ds_read_b32 v52, v48
    s_waitcnt lgkmcnt(1)
    v_smfmac_f32_16x16x64_bf16 v[0:3], v[136:139], v[72:79], v22
    v_smfmac_f32_16x16x64_bf16 v[60:63], v[136:139], v[80:87], v22
    v_smfmac_f32_16x16x64_bf16 v[6:9], v[136:139], v[88:95], v22
    v_smfmac_f32_16x16x64_bf16 v[10:13], v[136:139], v[96:103], v22
    s_cmp_lg_u32 s32, 0
    s_nop 3
    v_add_f32_dpp v144, v0, v2 quad_perm:[0,1,2,3] row_mask:0x1 bank_mask:0xf
    v_add_f32_dpp v145, v1, v3 quad_perm:[0,1,2,3] row_mask:0x1 bank_mask:0xf
    v_add_f32_dpp v144, v60, v62 quad_perm:[0,1,2,3] row_mask:0x2 bank_mask:0xf
    v_add_f32_dpp v145, v61, v63 quad_perm:[0,1,2,3] row_mask:0x2 bank_mask:0xf
    v_add_f32_dpp v144, v6, v8 quad_perm:[0,1,2,3] row_mask:0x4 bank_mask:0xf
    v_add_f32_dpp v145, v7, v9 quad_perm:[0,1,2,3] row_mask:0x4 bank_mask:0xf
    v_add_f32_dpp v144, v10, v12 quad_perm:[0,1,2,3] row_mask:0x8 bank_mask:0xf
    v_add_f32_dpp v145, v11, v13 quad_perm:[0,1,2,3] row_mask:0x8 bank_mask:0xf
    v_cvt_pk_bf16_f32 v14, v144, v145
    s_cbranch_scc1 L_fs_27
    buffer_store_dword v14, v45, s[20:23], s24 offen sc1
    s_branch L_fd_28
L_fs_27:
    buffer_store_dword v14, v45, s[20:23], s24 offen
L_fd_28:
    s_cmp_ge_u32 s3, 16
    s_cbranch_scc1 L_hdone
    buffer_load_dwordx2 v[140:141], v44, s[20:23], 0 offen sc1
    s_mov_b32 s24, s46
    s_mov_b32 s25, s47
    s_mov_b32 s26, 2048
    s_mov_b32 s27, 0x20000
    s_waitcnt lgkmcnt(0)
    v_fma_f32 v52, v23, v24, v52
    s_mov_b32 s30, 0
    s_waitcnt vmcnt(0)
    s_branch L_vw_31
L_vp_29:
    buffer_load_dwordx2 v[140:141], v44, s[20:23], 0 offen sc1
    s_add_u32 s30, s30, 1
    s_waitcnt vmcnt(0)
L_vw_31:
    v_max_u32 v144, v140, v141
    v_cmp_eq_u32 vcc, -1, v144
    s_cbranch_vccz L_vd_30
    s_cmp_lt_u32 s30, 1000000
    s_cbranch_scc1 L_vp_29
L_vd_30:
    v_lshlrev_b32 v136, 16, v140
    v_lshlrev_b32 v138, 16, v141
    v_and_b32 v137, 0xffff0000, v140
    v_and_b32 v139, 0xffff0000, v141
    v_add_f32_dpp v36, v136, v136 row_ror:8 row_mask:0xf bank_mask:0x3
    v_add_f32_dpp v38, v138, v138 row_ror:8 row_mask:0xf bank_mask:0x3
    v_add_f32_dpp v36, v137, v137 row_ror:8 row_mask:0xf bank_mask:0xc
    v_add_f32_dpp v38, v139, v139 row_ror:8 row_mask:0xf bank_mask:0xc
    s_nop 1
    v_permlane16_swap_b32 v36, v38
    v_add_f32 v36, v36, v38
    v_mov_b32 v38, v36
    s_nop 1
    v_permlane32_swap_b32 v36, v38
    v_add_f32 v36, v36, v38
    s_nop 1
    v_add_f32_dpp v36, v36, v36 quad_perm:[2,3,0,1] row_mask:0xf bank_mask:0xf
    s_nop 1
    v_add_f32_dpp v36, v36, v36 row_shl:4 row_mask:0xf bank_mask:0x5
    v_fma_f32 v36, v23, v36, v52
    s_mov_b64 exec, 0x03030303
    v_cvt_pk_bf16_f32 v38, v36, v36
    buffer_store_short v38, v49, s[24:27], 0 offen
    s_or_b32 s6, s3, s4
    s_cmp_lg_u32 s6, 0
    s_cbranch_scc1 L_noep
    s_mov_b64 exec, 1
    v_mov_b32 v10, 108544
    v_mov_b32 v11, s33
    buffer_store_dword v11, v10, s[16:19], 0 offen
L_noep:
    s_mov_b64 exec, -1
L_hdone:
L_end:
    s_endpgm
.section .rodata,"a"
.p2align 6
.amdhsa_kernel adaLN_cond__gqa_block_cached__mixer_channel_mlp__decode_kernel
  .amdhsa_next_free_vgpr 168
  .amdhsa_next_free_sgpr 102
  .amdhsa_accum_offset 168
  .amdhsa_group_segment_fixed_size 0
  .amdhsa_kernarg_size 120
  .amdhsa_user_sgpr_count 2
  .amdhsa_user_sgpr_kernarg_segment_ptr 1
  .amdhsa_system_sgpr_workgroup_id_x 1
.end_amdhsa_kernel
```
